```python
import torch

def _softmax(x, axis=-1):
    return torch.softmax(x, dim=axis)
def _gelu(x):
    return torch.nn.functional.gelu(x, approximate="tanh")
def _silu(x):
    return torch.nn.functional.silu(x)
def _sigmoid(x):
    return torch.sigmoid(x)
def _layernorm(x, axis=-1, eps=1e-5):
    m = x.mean(dim=axis, keepdim=True)
    v = x.var(dim=axis, keepdim=True, unbiased=False)
    return (x - m) / torch.sqrt(v + eps)
def _scatter_add(tgt, idx, src, axis=0):
    return tgt.clone().index_add_(axis, idx, src)
def _segment_sum(src, seg, n):
    out = torch.zeros((n,) + src.shape[1:], dtype=src.dtype)
    return out.index_add_(0, seg, src)
def _pad(x, pw):
    flat = tuple(v for pair in reversed(pw) for v in pair)
    return torch.nn.functional.pad(x, flat)

kernel_name = 'standalone__gqa_block_cached__near_ridge'

def setup_inputs():

    _w = (lambda a: (lambda t: t.to(torch.bfloat16) if t.is_floating_point() else t)(torch.as_tensor(a)))
    B, Sq, D = 16, 96, 448
    Hq, Hkv, Sk, Dh = 16, 8, 1024, 256
    assert Hq % Hkv == 0, (Hq, Hkv)
    return {
        "x": _w((lambda *s: torch.randn(*s, dtype=torch.bfloat16) * 0.8)(B, Sq, D)),
        "k_cache": _w((lambda *s: torch.randn(*s, dtype=torch.bfloat16) * 0.8)(B, Hkv, Sk, Dh)),
        "v_cache": _w((lambda *s: torch.randn(*s, dtype=torch.bfloat16) * 0.05)(B, Hkv, Sk, Dh)),
        "wq": _w((lambda *s: torch.randn(*s, dtype=torch.bfloat16) * 0.8)(D, Hq * Dh) * (D ** -0.5)),
        "wo": _w((lambda *s: torch.randn(*s, dtype=torch.bfloat16) * 0.05)(Hq * Dh, D) * ((Hq * Dh) ** -0.5)),
    }

def reference(x, k_cache, v_cache, wq, wo):
    B, Sq, D = x.shape
    Hq, Dh = 16, 256
    Hkv = k_cache.shape[1]
    rep = Hq // Hkv
    q = (lambda x, *d: x.permute(*d))((x @ wq).reshape(B, Sq, Hq, Dh), 0, 2, 1, 3)
    k = (lambda x, n, axis: torch.repeat_interleave(x, n, dim=axis))(k_cache, rep, axis=1)
    v = (lambda x, n, axis: torch.repeat_interleave(x, n, dim=axis))(v_cache, rep, axis=1)
    scores = torch.einsum("bhqd,bhkd->bhqk", q, k) * (Dh ** -0.5)
    p = _softmax(scores, axis=-1)
    o = torch.einsum("bhqk,bhkd->bhqd", p, v)
    return (lambda x, *d: x.permute(*d))(o, 0, 2, 1, 3).reshape(B, Sq, Hq * Dh) @ wo
```

```asm
; @launch grid=(256,1,1) block=(256,1,1) lds=163840
.amdgcn_target "amdgcn-amd-amdhsa--gfx950"
.text
.globl standalone__gqa_block_cached__near_ridge_kernel
.p2align 8
.type standalone__gqa_block_cached__near_ridge_kernel,@function
standalone__gqa_block_cached__near_ridge_kernel:
    s_load_dwordx8 s[4:11], s[0:1], 0
    s_load_dwordx4 s[12:15], s[0:1], 32
    s_load_dwordx2 s[16:17], s[0:1], 56
    s_cmp_ge_u32 s2, 256
    s_cbranch_scc1 L_exit
    v_lshrrev_b32 v2, 6, v0
    v_and_b32 v1, 63, v0
    v_readfirstlane_b32 s48, v2
    s_getpc_b64 s[18:19]
L_pc0:
    s_cmp_ge_u32 s2, 16
    s_cbranch_scc1 L_nocpf
    s_lshr_b32 s3, s2, 3
    s_lshl_b32 s3, s3, 8
    v_add_u32 v3, s3, v0
    v_lshlrev_b32 v3, 7, v3
    v_min_u32 v3, L_end-L_pc0-4, v3
    global_load_dword v0, v3, s[18:19]
L_nocpf:
    s_and_b32 s44, s2, 7
    s_lshr_b32 s49, s2, 3
    s_and_b32 s47, s49, 1
    s_lshr_b32 s45, s49, 1
    s_lshl_b32 s46, s44, 1
    s_add_u32 s46, s46, s47
    v_lshrrev_b32 v43, 2, v1
    v_and_b32 v44, 3, v1
    v_lshlrev_b32 v44, 7, v44
    v_min_u32 v43, 6, v43
    v_lshl_add_u32 v43, v43, 13, v44
    v_lshrrev_b32 v45, 3, v1
    v_and_b32 v47, 7, v1
    v_bfe_u32 v61, v1, 4, 2
    v_xor_b32 v61, v61, v47
    v_lshlrev_b32 v61, 4, v61
    s_movk_i32 s49, 896
    v_mad_u32_u24 v44, v45, s49, v61
    s_and_b32 s49, s48, 1
    s_lshl_b32 s49, s49, 6
    v_xor_b32 v44, s49, v44
    s_mul_i32 s49, s48, 21504
    v_add_u32 v35, s49, v44
    v_xor_b32 v36, 64, v35
    v_add_u32 v36, 7168, v36
    v_add_u32 v37, 14336, v35
    s_mul_i32 s58, s48, 3072
    s_add_u32 s58, s58, 65536
    s_lshl_b32 s55, s45, 2
    s_add_u32 s55, s55, s48
    s_mul_i32 s55, s55, 57344
    s_mul_i32 s52, s45, 86016
    s_lshl_b32 s49, s46, 9
    s_waitcnt lgkmcnt(0)
    s_add_u32 s32, s10, s49
    s_addc_u32 s33, s11, 0
    s_mov_b32 s34, 3662336
    s_mov_b32 s35, 0x20000
    s_add_u32 s20, s4, s52
    s_addc_u32 s21, s5, 0
    s_mov_b32 s22, 86016
    s_mov_b32 s23, 0x20000
    s_add_u32 m0, s58, 0
    s_nop 0
    buffer_load_dwordx4 v35, s[20:23], 0 offen lds
    s_add_u32 m0, s58, 1024
    s_nop 0
    buffer_load_dwordx4 v36, s[20:23], 0 offen lds
    s_add_u32 m0, s58, 2048
    s_nop 0
    buffer_load_dwordx4 v37, s[20:23], 0 offen lds
    buffer_load_dword v0, v43, s[32:35], s55 offen
    s_lshl_b32 s66, s45, 7
    s_add_u32 s66, s66, 23592960
    s_load_dword s64, s[16:17], s66
    v_bfe_u32 v43, v1, 4, 1
    v_lshlrev_b32 v43, 2, v43
    v_xor_b32 v46, v43, v47
    v_lshlrev_b32 v46, 4, v46
    v_lshl_add_u32 v46, s48, 7, v46
    v_lshl_add_u32 v34, v45, 13, v46
    v_lshl_add_u32 v12, v45, 9, v46
    v_lshl_add_u32 v10, v45, 9, v61
    v_lshl_add_u32 v10, s48, 14, v10
    v_xor_b32 v11, 64, v10
    s_lshl_b32 s53, s48, 14
    s_add_u32 s54, s53, 65536
    s_mov_b32 s57, 0
    s_lshl_b32 s49, s45, 3
    s_add_u32 s49, s49, s44
    s_lshl_b32 s49, s49, 19
    s_add_u32 s24, s6, s49
    s_addc_u32 s25, s7, 0
    s_mov_b32 s26, 524288
    s_mov_b32 s27, 0x20000
    s_add_u32 s28, s8, s49
    s_addc_u32 s29, s9, 0
    s_mov_b32 s30, 524288
    s_mov_b32 s31, 0x20000
    s_mul_i32 s49, s46, 229376
    s_add_u32 s36, s12, s49
    s_addc_u32 s37, s13, 0
    s_mov_b32 s38, 229376
    s_mov_b32 s39, 0x20000
    s_lshl_b32 s49, s45, 4
    s_add_u32 s49, s49, s46
    s_mul_i32 s49, s49, 86144
    s_add_u32 s49, s49, 128
    s_add_u32 s40, s16, s49
    s_addc_u32 s41, s17, 0
    s_mov_b32 s42, 86016
    s_mov_b32 s43, 0x20000
    s_mov_b32 s3, 0
    s_load_dword s97, s[24:25], s3
    s_mov_b32 s3, 0
    s_load_dword s97, s[28:29], s3
    s_mov_b32 s3, 0
    s_load_dword s97, s[36:37], s3
    s_mov_b32 s3, 229372
    s_load_dword s97, s[36:37], s3
    s_mul_i32 s3, s45, 1378304
    s_load_dword s97, s[16:17], s3
    s_add_u32 s3, s3, 1378304
    s_load_dword s97, s[16:17], s3
    s_mul_i32 s3, s45, 86016
    s_load_dword s97, s[14:15], s3
    s_add_u32 s3, s3, 86012
    s_load_dword s97, s[14:15], s3
    v_bfe_u32 v6, v1, 5, 1
    v_lshlrev_b32 v6, 9, v6
    v_bfe_u32 v43, v1, 2, 2
    v_lshl_or_b32 v6, v43, 7, v6
    v_bfe_u32 v43, v1, 3, 1
    v_lshl_or_b32 v6, v43, 6, v6
    v_bfe_u32 v43, v1, 4, 1
    v_lshl_or_b32 v6, v43, 5, v6
    v_bfe_u32 v43, v1, 0, 2
    v_lshl_or_b32 v6, v43, 3, v6
    v_add_u32 v6, s54, v6
    v_xor_b32 v7, 64, v6
    v_bfe_u32 v32, v1, 5, 1
    v_lshlrev_b32 v32, 10, v32
    v_bfe_u32 v43, v1, 2, 2
    v_lshl_or_b32 v32, v43, 7, v32
    v_bfe_u32 v43, v1, 3, 1
    v_lshl_or_b32 v32, v43, 6, v32
    v_bfe_u32 v43, v1, 4, 1
    v_lshl_or_b32 v32, v43, 5, v32
    v_bfe_u32 v43, v1, 0, 1
    v_lshl_or_b32 v32, v43, 4, v32
    v_bfe_u32 v43, v1, 1, 1
    v_lshl_or_b32 v32, v43, 3, v32
    v_add_u32 v32, s53, v32
    v_xor_b32 v33, 64, v32
    v_bfe_u32 v28, v1, 1, 3
    v_bfe_u32 v43, v1, 5, 1
    v_xor_b32 v28, v28, v43
    v_lshlrev_b32 v28, 4, v28
    v_and_b32 v43, 31, v1
    v_lshl_or_b32 v28, v43, 7, v28
    v_add_u32 v2, s53, v28
    v_add_u32 v28, 65536, v28
    v_xor_b32 v3, 32, v2
    v_xor_b32 v29, 32, v28
    v_xor_b32 v4, 64, v2
    v_xor_b32 v30, 64, v28
    v_xor_b32 v5, 96, v2
    v_xor_b32 v31, 96, v28
    v_lshlrev_b32 v43, 4, v1
    v_add_u32 v8, 131072, v43
    s_mul_i32 s49, s48, 6144
    v_add_u32 v9, s49, v8
    v_add_u32 v38, 65536, v43
    v_add_u32 v39, s54, v43
    v_and_b32 v40, 31, v1
    v_lshlrev_b32 v40, 4, v40
    v_add_u32 v40, 156672, v40
    v_lshl_add_u32 v41, s48, 2, v40
    v_mov_b32 v43, 0
    ds_write_b32 v8, v43 offset:24576
    s_mov_b32 s50, 0x3db8aa3b
    s_mov_b32 s56, 4294963200
    s_mov_b32 s60, 0
    s_mov_b32 s61, 4096
    s_mov_b32 s62, 8192
    s_mov_b32 s63, 12288
    s_add_u32 m0, s53, 8192
    s_nop 0
    buffer_load_dwordx4 v34, s[32:35], s57 offen lds
    s_add_u32 s57, s57, 65536
    s_add_u32 m0, s53, 9216
    s_nop 0
    buffer_load_dwordx4 v34, s[32:35], s57 offen lds
    s_add_u32 s57, s57, 65536
    s_add_u32 m0, s53, 10240
    s_nop 0
    buffer_load_dwordx4 v34, s[32:35], s57 offen lds
    s_add_u32 s57, s57, 65536
    s_add_u32 m0, s53, 11264
    s_nop 0
    buffer_load_dwordx4 v34, s[32:35], s57 offen lds
    s_add_u32 s57, s57, 65536
    s_add_u32 m0, s58, 12160
    s_nop 0
    buffer_load_dwordx4 v35, s[20:23], 0 offen offset:128 lds
    s_add_u32 m0, s58, 13184
    s_nop 0
    buffer_load_dwordx4 v36, s[20:23], 0 offen offset:128 lds
    s_add_u32 m0, s58, 14208
    s_nop 0
    buffer_load_dwordx4 v37, s[20:23], 0 offen offset:128 lds
    s_add_u32 m0, s53, 12288
    s_nop 0
    buffer_load_dwordx4 v34, s[32:35], s57 offen lds
    s_add_u32 s57, s57, 65536
    s_add_u32 m0, s53, 13312
    s_nop 0
    buffer_load_dwordx4 v34, s[32:35], s57 offen lds
    s_add_u32 s57, s57, 65536
    s_add_u32 m0, s53, 14336
    s_nop 0
    buffer_load_dwordx4 v34, s[32:35], s57 offen lds
    s_add_u32 s57, s57, 65536
    s_add_u32 m0, s53, 15360
    s_nop 0
    buffer_load_dwordx4 v34, s[32:35], s57 offen lds
    s_add_u32 s57, s57, 65536
    s_waitcnt lgkmcnt(0)
    s_add_u32 s64, s64, 1
    s_waitcnt lgkmcnt(0)
    s_waitcnt vmcnt(12)
    s_barrier
    ds_read_b128 a[0:3], v28 offset:0
    s_waitcnt vmcnt(9)
    ds_read_b64_tr_b16 a[192:193], v32 offset:8192
    ds_read_b64_tr_b16 a[194:195], v32 offset:8704
    s_waitcnt lgkmcnt(0)
    v_mfma_f32_32x32x16_bf16 v[160:175], a[192:195], a[0:3], 0
    ds_read_b128 a[4:7], v28 offset:4096
    s_add_u32 m0, s58, 24320
    ds_read_b64_tr_b16 a[196:197], v33 offset:8192
    buffer_load_dwordx4 v35, s[20:23], 0 offen offset:256 lds
    s_waitcnt lgkmcnt(1)
    v_mfma_f32_32x32x16_bf16 v[176:191], a[192:195], a[4:7], 0
    ds_read_b128 a[8:11], v28 offset:8192
    ds_read_b128 a[12:15], v29 offset:0
    ds_read_b128 a[16:19], v29 offset:4096
    s_waitcnt lgkmcnt(2)
    v_mfma_f32_32x32x16_bf16 v[192:207], a[192:195], a[8:11], 0
    ds_read_b64_tr_b16 a[198:199], v33 offset:8704
    s_waitcnt vmcnt(8)
    ds_read_b64_tr_b16 a[200:201], v32 offset:10240
    s_add_u32 m0, s58, 25344
    s_waitcnt lgkmcnt(1)
    v_mfma_f32_32x32x16_bf16 v[208:223], a[196:199], a[0:3], 0
    ds_read_b64_tr_b16 a[202:203], v32 offset:10752
    ds_read_b64_tr_b16 a[204:205], v33 offset:10240
    ds_read_b128 a[20:23], v29 offset:8192
    buffer_load_dwordx4 v36, s[20:23], 0 offen offset:256 lds
    v_mfma_f32_32x32x16_bf16 v[224:239], a[196:199], a[4:7], 0
    ds_read_b128 a[24:27], v30 offset:0
    ds_read_b128 a[28:31], v30 offset:4096
    ds_read_b128 a[32:35], v30 offset:8192
    s_add_u32 m0, s58, 26368
    v_mfma_f32_32x32x16_bf16 v[240:255], a[196:199], a[8:11], 0
    ds_read_b64_tr_b16 a[206:207], v33 offset:10752
    s_waitcnt vmcnt(4)
    ds_read_b64_tr_b16 a[208:209], v32 offset:12288
    buffer_load_dwordx4 v37, s[20:23], 0 offen offset:256 lds
    s_waitcnt lgkmcnt(7)
    v_mfma_f32_32x32x16_bf16 v[160:175], a[200:203], a[12:15], v[160:175]
    ds_read_b64_tr_b16 a[210:211], v32 offset:12800
    ds_read_b64_tr_b16 a[212:213], v33 offset:12288
    ds_read_b64_tr_b16 a[214:215], v33 offset:12800
    s_add_u32 m0, s53, 0
    v_mfma_f32_32x32x16_bf16 v[176:191], a[200:203], a[16:19], v[176:191]
    buffer_load_dwordx4 v34, s[32:35], s57 offen lds
    s_add_u32 s57, s57, 65536
    s_add_u32 m0, s53, 1024
    ds_read_b128 a[36:39], v31 offset:0
    buffer_load_dwordx4 v34, s[32:35], s57 offen lds
    s_waitcnt lgkmcnt(9)
    v_mfma_f32_32x32x16_bf16 v[192:207], a[200:203], a[20:23], v[192:207]
    ds_read_b128 a[40:43], v31 offset:4096
    s_add_u32 s57, s57, 65536
    s_add_u32 m0, s53, 2048
    s_nop 0
    buffer_load_dwordx4 v34, s[32:35], s57 offen lds
    s_waitcnt lgkmcnt(6)
    v_mfma_f32_32x32x16_bf16 v[208:223], a[204:207], a[12:15], v[208:223]
    ds_read_b128 a[44:47], v31 offset:8192
    s_waitcnt vmcnt(6)
    ds_read_b64_tr_b16 a[216:217], v32 offset:14336
    s_add_u32 s57, s57, 65536
    v_mfma_f32_32x32x16_bf16 v[224:239], a[204:207], a[16:19], v[224:239]
    s_add_u32 m0, s53, 3072
    ds_read_b64_tr_b16 a[218:219], v32 offset:14848
    buffer_load_dwordx4 v34, s[32:35], s57 offen lds
    v_mfma_f32_32x32x16_bf16 v[240:255], a[204:207], a[20:23], v[240:255]
    ds_read_b64_tr_b16 a[220:221], v33 offset:14336
    s_add_u32 s57, s57, 65536
    s_add_u32 m0, s58, 36480
    s_nop 0
    buffer_load_dwordx4 v35, s[20:23], 0 offen offset:384 lds
    s_waitcnt lgkmcnt(7)
    v_mfma_f32_32x32x16_bf16 v[160:175], a[208:211], a[24:27], v[160:175]
    ds_read_b64_tr_b16 a[222:223], v33 offset:14848
    s_add_u32 m0, s58, 37504
    s_nop 0
    buffer_load_dwordx4 v36, s[20:23], 0 offen offset:384 lds
    v_mfma_f32_32x32x16_bf16 v[176:191], a[208:211], a[28:31], v[176:191]
    s_add_u32 m0, s58, 38528
    s_nop 0
    buffer_load_dwordx4 v37, s[20:23], 0 offen offset:384 lds
    s_add_u32 m0, s53, 4096
    s_nop 0
    buffer_load_dwordx4 v34, s[32:35], s57 offen lds
    s_add_u32 s57, s57, 65536
    s_add_u32 m0, s53, 5120
    v_mfma_f32_32x32x16_bf16 v[192:207], a[208:211], a[32:35], v[192:207]
    s_waitcnt vmcnt(6)
    ds_read_b64_tr_b16 a[224:225], v32 offset:0
    buffer_load_dwordx4 v34, s[32:35], s57 offen lds
    s_barrier
    s_add_u32 s57, s57, 65536
    s_waitcnt lgkmcnt(5)
    v_mfma_f32_32x32x16_bf16 v[208:223], a[212:215], a[24:27], v[208:223]
    ds_read_b128 a[48:51], v28 offset:12288
    s_add_u32 m0, s53, 6144
    ds_read_b64_tr_b16 a[226:227], v32 offset:512
    v_mfma_f32_32x32x16_bf16 v[224:239], a[212:215], a[28:31], v[224:239]
    ds_read_b128 a[52:55], v28 offset:16384
    ds_read_b64_tr_b16 a[228:229], v33 offset:0
    buffer_load_dwordx4 v34, s[32:35], s57 offen lds
    ds_read_b128 a[56:59], v28 offset:20480
    v_mfma_f32_32x32x16_bf16 v[240:255], a[212:215], a[32:35], v[240:255]
    s_add_u32 s57, s57, 65536
    s_add_u32 m0, s53, 7168
    ds_read_b64_tr_b16 a[230:231], v33 offset:512
    s_waitcnt lgkmcnt(7)
    v_mfma_f32_32x32x16_bf16 v[160:175], a[216:219], a[36:39], v[160:175]
    buffer_load_dwordx4 v34, s[32:35], s57 offen lds
    s_add_u32 s57, s57, 65536
    s_add_u32 m0, s58, 48640
    s_nop 0
    buffer_load_dwordx4 v35, s[20:23], 0 offen offset:512 lds
    s_add_u32 m0, s58, 49664
    v_mfma_f32_32x32x16_bf16 v[176:191], a[216:219], a[40:43], v[176:191]
    buffer_load_dwordx4 v36, s[20:23], 0 offen offset:512 lds
    s_add_u32 m0, s58, 50688
    s_nop 0
    buffer_load_dwordx4 v37, s[20:23], 0 offen offset:512 lds
    s_add_u32 m0, s58, 60800
    s_nop 0
    buffer_load_dwordx4 v35, s[20:23], 0 offen offset:640 lds
    v_mfma_f32_32x32x16_bf16 v[192:207], a[216:219], a[44:47], v[192:207]
    s_waitcnt vmcnt(11)
    ds_read_b64_tr_b16 a[232:233], v32 offset:2048
    s_add_u32 m0, s58, 61824
    ds_read_b64_tr_b16 a[234:235], v32 offset:2560
    v_mfma_f32_32x32x16_bf16 v[208:223], a[220:223], a[36:39], v[208:223]
    buffer_load_dwordx4 v36, s[20:23], 0 offen offset:640 lds
    s_add_u32 m0, s58, 62848
    ds_read_b64_tr_b16 a[236:237], v33 offset:2048
    buffer_load_dwordx4 v37, s[20:23], 0 offen offset:640 lds
    v_mfma_f32_32x32x16_bf16 v[224:239], a[220:223], a[40:43], v[224:239]
    ds_read_b64_tr_b16 a[238:239], v33 offset:2560
    s_add_u32 m0, s58, 72960
    ds_read_b128 a[60:63], v29 offset:12288
    v_mfma_f32_32x32x16_bf16 v[240:255], a[220:223], a[44:47], v[240:255]
    buffer_load_dwordx4 v35, s[20:23], 0 offen offset:768 lds
    s_add_u32 m0, s58, 73984
    ds_read_b128 a[64:67], v29 offset:16384
    s_waitcnt lgkmcnt(6)
    v_mfma_f32_32x32x16_bf16 v[160:175], a[224:227], a[48:51], v[160:175]
    buffer_load_dwordx4 v36, s[20:23], 0 offen offset:768 lds
    s_add_u32 m0, s58, 75008
    ds_read_b128 a[68:71], v29 offset:20480
    buffer_load_dwordx4 v37, s[20:23], 0 offen offset:768 lds
    v_mfma_f32_32x32x16_bf16 v[176:191], a[224:227], a[52:55], v[176:191]
    s_add_u32 m0, s53, 8192
    s_nop 0
    buffer_load_dwordx4 v34, s[32:35], s57 offen lds
    s_add_u32 s57, s57, 65536
    s_add_u32 m0, s53, 9216
    s_nop 0
    buffer_load_dwordx4 v34, s[32:35], s57 offen lds
    v_mfma_f32_32x32x16_bf16 v[192:207], a[224:227], a[56:59], v[192:207]
    s_add_u32 s57, s57, 65536
    s_add_u32 m0, s53, 10240
    s_nop 0
    buffer_load_dwordx4 v34, s[32:35], s57 offen lds
    s_add_u32 s57, s57, 65536
    s_add_u32 m0, s53, 11264
    v_mfma_f32_32x32x16_bf16 v[208:223], a[228:231], a[48:51], v[208:223]
    buffer_load_dwordx4 v34, s[32:35], s57 offen lds
    s_add_u32 s57, s57, 65536
    s_add_u32 m0, s53, 12288
    s_nop 0
    buffer_load_dwordx4 v34, s[32:35], s57 offen lds
    s_add_u32 s57, s57, 65536
    v_mfma_f32_32x32x16_bf16 v[224:239], a[228:231], a[52:55], v[224:239]
    s_add_u32 m0, s53, 13312
    s_nop 0
    buffer_load_dwordx4 v34, s[32:35], s57 offen lds
    s_add_u32 s57, s57, 65536
    s_add_u32 m0, s53, 14336
    s_nop 0
    buffer_load_dwordx4 v34, s[32:35], s57 offen lds
    v_mfma_f32_32x32x16_bf16 v[240:255], a[228:231], a[56:59], v[240:255]
    s_add_u32 s57, s57, 65536
    s_add_u32 m0, s53, 15360
    s_nop 0
    buffer_load_dwordx4 v34, s[32:35], s57 offen lds
    s_add_u32 s57, s57, 65536
    s_add_u32 m0, s53, 0
    s_nop 0
    buffer_load_dwordx4 v34, s[32:35], s57 offen lds
    s_waitcnt lgkmcnt(0)
    v_mfma_f32_32x32x16_bf16 v[160:175], a[232:235], a[60:63], v[160:175]
    s_add_u32 s57, s57, 65536
    s_add_u32 m0, s53, 1024
    s_nop 0
    buffer_load_dwordx4 v34, s[32:35], s57 offen lds
    s_add_u32 s57, s57, 65536
    s_add_u32 m0, s53, 2048
    s_nop 0
    buffer_load_dwordx4 v34, s[32:35], s57 offen lds
    v_mfma_f32_32x32x16_bf16 v[176:191], a[232:235], a[64:67], v[176:191]
    s_add_u32 s57, s57, 65536
    s_add_u32 m0, s53, 3072
    s_waitcnt vmcnt(22)
    ds_read_b64_tr_b16 a[240:241], v32 offset:4096
    ds_read_b64_tr_b16 a[242:243], v32 offset:4608
    v_mfma_f32_32x32x16_bf16 v[192:207], a[232:235], a[68:71], v[192:207]
    ds_read_b128 a[72:75], v30 offset:12288
    ds_read_b64_tr_b16 a[244:245], v33 offset:4096
    ds_read_b64_tr_b16 a[246:247], v33 offset:4608
    buffer_load_dwordx4 v34, s[32:35], s57 offen lds
    v_mfma_f32_32x32x16_bf16 v[208:223], a[236:239], a[60:63], v[208:223]
    ds_read_b128 a[76:79], v30 offset:16384
    s_add_u32 s57, s57, 65536
    s_add_u32 m0, s53, 4096
    v_mfma_f32_32x32x16_bf16 v[224:239], a[236:239], a[64:67], v[224:239]
    ds_read_b128 a[80:83], v30 offset:20480
    s_waitcnt vmcnt(21)
    ds_read_b64_tr_b16 a[248:249], v32 offset:6144
    ds_read_b64_tr_b16 a[250:251], v32 offset:6656
    v_mfma_f32_32x32x16_bf16 v[240:255], a[236:239], a[68:71], v[240:255]
    s_waitcnt lgkmcnt(4)
    buffer_load_dwordx4 v34, s[32:35], s57 offen lds
    s_add_u32 s57, s57, 65536
    s_add_u32 m0, s53, 5120
    ds_read_b64_tr_b16 a[252:253], v33 offset:6144
    v_mfma_f32_32x32x16_bf16 v[160:175], a[240:243], a[72:75], v[160:175]
    ds_read_b64_tr_b16 a[254:255], v33 offset:6656
    buffer_load_dwordx4 v34, s[32:35], s57 offen lds
    s_add_u32 s57, s57, 65536
    s_add_u32 m0, s53, 6144
    s_waitcnt vmcnt(12)
    ds_read_b64_tr_b16 v[48:49], v32 offset:8192
    s_waitcnt lgkmcnt(6)
    v_mfma_f32_32x32x16_bf16 v[176:191], a[240:243], a[76:79], v[176:191]
    ds_read_b64_tr_b16 v[50:51], v32 offset:8704
    ds_read_b128 a[84:87], v31 offset:12288
    ds_read_b64_tr_b16 v[52:53], v33 offset:8192
    s_waitcnt lgkmcnt(8)
    v_mfma_f32_32x32x16_bf16 v[192:207], a[240:243], a[80:83], v[192:207]
    ds_read_b128 a[88:91], v31 offset:16384
    ds_read_b64_tr_b16 v[54:55], v33 offset:8704
    ds_read_b128 a[92:95], v31 offset:20480
    v_mfma_f32_32x32x16_bf16 v[208:223], a[244:247], a[72:75], v[208:223]
    s_waitcnt lgkmcnt(7)
    buffer_load_dwordx4 v34, s[32:35], s57 offen lds
    s_add_u32 s57, s57, 65536
    s_add_u32 m0, s53, 7168
    s_nop 0
    buffer_load_dwordx4 v34, s[32:35], s57 offen lds
    s_add_u32 s57, s57, 65536
    v_mfma_f32_32x32x16_bf16 v[224:239], a[244:247], a[76:79], v[224:239]
    s_add_u32 m0, s53, 8192
    s_waitcnt vmcnt(12)
    ds_read_b64_tr_b16 v[56:57], v32 offset:10240
    ds_read_b64_tr_b16 v[58:59], v32 offset:10752
    s_barrier
    v_mfma_f32_32x32x16_bf16 v[240:255], a[244:247], a[80:83], v[240:255]
    s_waitcnt lgkmcnt(3)
    buffer_load_dwordx4 v34, s[32:35], s57 offen lds
    s_add_u32 s57, s57, 65536
    s_add_u32 m0, s53, 9216
    ds_read_b64_tr_b16 v[60:61], v33 offset:10240
    buffer_load_dwordx4 v34, s[32:35], s57 offen lds
    v_mfma_f32_32x32x16_bf16 v[160:175], a[248:251], a[84:87], v[160:175]
    ds_read_b64_tr_b16 v[62:63], v33 offset:10752
    s_add_u32 s57, s57, 65536
    s_add_u32 m0, s53, 10240
    ds_read_b128 a[0:3], v28 offset:24576
    v_mfma_f32_32x32x16_bf16 v[176:191], a[248:251], a[88:91], v[176:191]
    ds_read_b128 a[4:7], v28 offset:28672
    ds_read_b128 a[8:11], v28 offset:32768
    s_waitcnt lgkmcnt(7)
    v_mfma_f32_32x32x16_bf16 v[192:207], a[248:251], a[92:95], v[192:207]
    s_waitcnt vmcnt(12)
    ds_read_b64_tr_b16 v[64:65], v32 offset:12288
    ds_read_b64_tr_b16 v[66:67], v32 offset:12800
    ds_read_b64_tr_b16 v[68:69], v33 offset:12288
    v_mfma_f32_32x32x16_bf16 v[208:223], a[252:255], a[84:87], v[208:223]
    s_waitcnt lgkmcnt(6)
    buffer_load_dwordx4 v34, s[32:35], s57 offen lds
    s_add_u32 s57, s57, 65536
    s_add_u32 m0, s53, 11264
    ds_read_b64_tr_b16 v[70:71], v33 offset:12800
    buffer_load_dwordx4 v34, s[32:35], s57 offen lds
    v_mfma_f32_32x32x16_bf16 v[224:239], a[252:255], a[88:91], v[224:239]
    s_add_u32 s57, s57, 65536
    s_add_u32 m0, s53, 12288
    ds_read_b128 a[12:15], v29 offset:24576
    ds_read_b128 a[16:19], v29 offset:28672
    v_mfma_f32_32x32x16_bf16 v[240:255], a[252:255], a[92:95], v[240:255]
    s_waitcnt vmcnt(12)
    ds_read_b64_tr_b16 v[72:73], v32 offset:14336
    ds_read_b128 a[20:23], v29 offset:32768
    s_waitcnt lgkmcnt(10)
    v_mfma_f32_32x32x16_bf16 v[160:175], v[48:51], a[0:3], v[160:175]
    s_waitcnt lgkmcnt(4)
    buffer_load_dwordx4 v34, s[32:35], s57 offen lds
    s_add_u32 s57, s57, 65536
    s_add_u32 m0, s53, 13312
    ds_read_b64_tr_b16 v[74:75], v32 offset:14848
    v_mfma_f32_32x32x16_bf16 v[176:191], v[48:51], a[4:7], v[176:191]
    ds_read_b64_tr_b16 v[76:77], v33 offset:14336
    ds_read_b64_tr_b16 v[78:79], v33 offset:14848
    buffer_load_dwordx4 v34, s[32:35], s57 offen lds
    s_add_u32 s57, s57, 65536
    v_mfma_f32_32x32x16_bf16 v[192:207], v[48:51], a[8:11], v[192:207]
    s_add_u32 m0, s53, 14336
    s_waitcnt vmcnt(12)
    ds_read_b64_tr_b16 v[80:81], v32 offset:0
    ds_read_b64_tr_b16 v[82:83], v32 offset:512
    v_mfma_f32_32x32x16_bf16 v[208:223], v[52:55], a[0:3], v[208:223]
    ds_read_b64_tr_b16 v[84:85], v33 offset:0
    ds_read_b128 a[24:27], v30 offset:24576
    v_mfma_f32_32x32x16_bf16 v[224:239], v[52:55], a[4:7], v[224:239]
    s_waitcnt lgkmcnt(4)
    buffer_load_dwordx4 v34, s[32:35], s57 offen lds
    s_add_u32 s57, s57, 65536
    s_add_u32 m0, s53, 15360
    ds_read_b64_tr_b16 v[86:87], v33 offset:512
    buffer_load_dwordx4 v34, s[32:35], s57 offen lds
    s_add_u32 s57, s57, 65536
    v_mfma_f32_32x32x16_bf16 v[240:255], v[52:55], a[8:11], v[240:255]
    s_add_u32 m0, s53, 0
    ds_read_b128 a[28:31], v30 offset:28672
    ds_read_b128 a[32:35], v30 offset:32768
    v_mfma_f32_32x32x16_bf16 v[160:175], v[56:59], a[12:15], v[160:175]
    s_waitcnt vmcnt(12)
    ds_read_b64_tr_b16 v[88:89], v32 offset:2048
    ds_read_b64_tr_b16 v[90:91], v32 offset:2560
    ds_read_b64_tr_b16 v[92:93], v33 offset:2048
    v_mfma_f32_32x32x16_bf16 v[176:191], v[56:59], a[16:19], v[176:191]
    s_waitcnt lgkmcnt(5)
    buffer_load_dwordx4 v34, s[32:35], s57 offen lds
    s_add_u32 s57, s57, 65536
    s_add_u32 m0, s53, 1024
    ds_read_b64_tr_b16 v[94:95], v33 offset:2560
    buffer_load_dwordx4 v34, s[32:35], s57 offen lds
    s_add_u32 s57, s57, 65536
    v_mfma_f32_32x32x16_bf16 v[192:207], v[56:59], a[20:23], v[192:207]
    s_add_u32 m0, s53, 2048
    ds_read_b128 a[36:39], v31 offset:24576
    ds_read_b128 a[40:43], v31 offset:28672
    v_mfma_f32_32x32x16_bf16 v[208:223], v[60:63], a[12:15], v[208:223]
    ds_read_b128 a[44:47], v31 offset:32768
    s_waitcnt vmcnt(12)
    ds_read_b64_tr_b16 v[96:97], v32 offset:4096
    ds_read_b64_tr_b16 v[98:99], v32 offset:4608
    v_mfma_f32_32x32x16_bf16 v[224:239], v[60:63], a[16:19], v[224:239]
    s_waitcnt lgkmcnt(5)
    buffer_load_dwordx4 v34, s[32:35], s57 offen lds
    s_add_u32 s57, s57, 65536
    s_add_u32 m0, s53, 3072
    ds_read_b64_tr_b16 v[100:101], v33 offset:4096
    ds_read_b64_tr_b16 v[102:103], v33 offset:4608
    v_mfma_f32_32x32x16_bf16 v[240:255], v[60:63], a[20:23], v[240:255]
    buffer_load_dwordx4 v34, s[32:35], s57 offen lds
    s_add_u32 s57, s57, 65536
    s_add_u32 m0, s53, 4096
    s_barrier
    ds_read_b128 a[48:51], v28 offset:36864
    v_mfma_f32_32x32x16_bf16 v[160:175], v[64:67], a[24:27], v[160:175]
    s_waitcnt vmcnt(12)
    ds_read_b64_tr_b16 v[104:105], v32 offset:6144
    ds_read_b128 a[52:55], v28 offset:40960
    ds_read_b64_tr_b16 v[106:107], v32 offset:6656
    v_mfma_f32_32x32x16_bf16 v[176:191], v[64:67], a[28:31], v[176:191]
    s_waitcnt lgkmcnt(4)
    buffer_load_dwordx4 v34, s[32:35], s57 offen lds
    s_add_u32 s57, s57, 65536
    s_add_u32 m0, s53, 5120
    ds_read_b128 a[56:59], v28 offset:45056
    buffer_load_dwordx4 v34, s[32:35], s57 offen lds
    v_mfma_f32_32x32x16_bf16 v[192:207], v[64:67], a[32:35], v[192:207]
    ds_read_b64_tr_b16 v[108:109], v33 offset:6144
    ds_read_b64_tr_b16 v[110:111], v33 offset:6656
    s_add_u32 s57, s57, 65536
    v_mfma_f32_32x32x16_bf16 v[208:223], v[68:71], a[24:27], v[208:223]
    s_add_u32 m0, s53, 6144
    s_waitcnt vmcnt(12)
    ds_read_b64_tr_b16 a[128:129], v32 offset:8192
    ds_read_b64_tr_b16 a[130:131], v32 offset:8704
    ds_read_b64_tr_b16 a[132:133], v33 offset:8192
    v_mfma_f32_32x32x16_bf16 v[224:239], v[68:71], a[28:31], v[224:239]
    ds_read_b64_tr_b16 a[134:135], v33 offset:8704
    ds_read_b128 a[60:63], v29 offset:36864
    ds_read_b128 a[64:67], v29 offset:40960
    v_mfma_f32_32x32x16_bf16 v[240:255], v[68:71], a[32:35], v[240:255]
    s_waitcnt lgkmcnt(6)
    buffer_load_dwordx4 v34, s[32:35], s57 offen lds
    s_add_u32 s57, s57, 65536
    s_add_u32 m0, s53, 7168
    s_nop 0
    buffer_load_dwordx4 v34, s[32:35], s57 offen lds
    s_add_u32 s57, s57, 65536
    v_mfma_f32_32x32x16_bf16 v[160:175], v[72:75], a[36:39], v[160:175]
    s_add_u32 m0, s53, 8192
    ds_read_b128 a[68:71], v29 offset:45056
    s_waitcnt vmcnt(12)
    ds_read_b64_tr_b16 a[136:137], v32 offset:10240
    ds_read_b64_tr_b16 a[138:139], v32 offset:10752
    v_mfma_f32_32x32x16_bf16 v[176:191], v[72:75], a[40:43], v[176:191]
    s_waitcnt lgkmcnt(5)
    buffer_load_dwordx4 v34, s[32:35], s57 offen lds
    s_add_u32 s57, s57, 65536
    s_add_u32 m0, s53, 9216
    ds_read_b64_tr_b16 a[140:141], v33 offset:10240
    ds_read_b64_tr_b16 a[142:143], v33 offset:10752
    v_mfma_f32_32x32x16_bf16 v[192:207], v[72:75], a[44:47], v[192:207]
    buffer_load_dwordx4 v34, s[32:35], s57 offen lds
    s_add_u32 s57, s57, 65536
    s_add_u32 m0, s53, 10240
    ds_read_b128 a[72:75], v30 offset:36864
    ds_read_b128 a[76:79], v30 offset:40960
    v_mfma_f32_32x32x16_bf16 v[208:223], v[76:79], a[36:39], v[208:223]
    ds_read_b128 a[80:83], v30 offset:45056
    s_waitcnt vmcnt(12)
    ds_read_b64_tr_b16 a[144:145], v32 offset:12288
    v_mfma_f32_32x32x16_bf16 v[224:239], v[76:79], a[40:43], v[224:239]
    s_waitcnt lgkmcnt(4)
    buffer_load_dwordx4 v34, s[32:35], s57 offen lds
    s_add_u32 s57, s57, 65536
    s_add_u32 m0, s53, 11264
    ds_read_b64_tr_b16 a[146:147], v32 offset:12800
    buffer_load_dwordx4 v34, s[32:35], s57 offen lds
    v_mfma_f32_32x32x16_bf16 v[240:255], v[76:79], a[44:47], v[240:255]
    ds_read_b64_tr_b16 a[148:149], v33 offset:12288
    ds_read_b64_tr_b16 a[150:151], v33 offset:12800
    s_add_u32 s57, s57, 65536
    s_add_u32 m0, s53, 12288
    v_mfma_f32_32x32x16_bf16 v[160:175], v[80:83], a[48:51], v[160:175]
    v_mfma_f32_32x32x16_bf16 v[176:191], v[80:83], a[52:55], v[176:191]
    s_waitcnt vmcnt(12)
    ds_read_b64_tr_b16 a[152:153], v32 offset:14336
    v_mfma_f32_32x32x16_bf16 v[192:207], v[80:83], a[56:59], v[192:207]
    s_waitcnt lgkmcnt(1)
    buffer_load_dwordx4 v34, s[32:35], s57 offen lds
    s_add_u32 s57, s57, 65536
    s_add_u32 m0, s53, 13312
    ds_read_b128 a[84:87], v31 offset:36864
    v_mfma_f32_32x32x16_bf16 v[208:223], v[84:87], a[48:51], v[208:223]
    ds_read_b64_tr_b16 a[154:155], v32 offset:14848
    ds_read_b128 a[88:91], v31 offset:40960
    ds_read_b64_tr_b16 a[156:157], v33 offset:14336
    buffer_load_dwordx4 v34, s[32:35], s57 offen lds
    v_mfma_f32_32x32x16_bf16 v[224:239], v[84:87], a[52:55], v[224:239]
    ds_read_b128 a[92:95], v31 offset:45056
    ds_read_b64_tr_b16 a[158:159], v33 offset:14848
    s_add_u32 s57, s57, 65536
    s_add_u32 m0, s53, 14336
    v_mfma_f32_32x32x16_bf16 v[240:255], v[84:87], a[56:59], v[240:255]
    v_mfma_f32_32x32x16_bf16 v[160:175], v[88:91], a[60:63], v[160:175]
    s_waitcnt vmcnt(12)
    ds_read_b64_tr_b16 a[160:161], v32 offset:0
    ds_read_b64_tr_b16 a[162:163], v32 offset:512
    v_mfma_f32_32x32x16_bf16 v[176:191], v[88:91], a[64:67], v[176:191]
    s_waitcnt lgkmcnt(2)
    buffer_load_dwordx4 v34, s[32:35], s57 offen lds
    s_add_u32 s57, s57, 65536
    s_add_u32 m0, s53, 15360
    ds_read_b64_tr_b16 a[164:165], v33 offset:0
    buffer_load_dwordx4 v34, s[32:35], s57 offen lds
    v_mfma_f32_32x32x16_bf16 v[192:207], v[88:91], a[68:71], v[192:207]
    ds_read_b64_tr_b16 a[166:167], v33 offset:512
    s_add_u32 s57, s57, 65536
    s_add_u32 m0, s53, 0
    s_barrier
    ds_read_b128 a[0:3], v28 offset:49152
    v_mfma_f32_32x32x16_bf16 v[208:223], v[92:95], a[60:63], v[208:223]
    ds_read_b128 a[4:7], v28 offset:53248
    ds_read_b128 a[8:11], v28 offset:57344
    v_mfma_f32_32x32x16_bf16 v[224:239], v[92:95], a[64:67], v[224:239]
    s_waitcnt vmcnt(12)
    ds_read_b64_tr_b16 a[168:169], v32 offset:2048
    v_mfma_f32_32x32x16_bf16 v[240:255], v[92:95], a[68:71], v[240:255]
    s_waitcnt lgkmcnt(4)
    buffer_load_dwordx4 v10, s[24:27], s60 offen nt lds
    s_add_u32 m0, s53, 1024
    ds_read_b64_tr_b16 a[170:171], v32 offset:2560
    ds_read_b64_tr_b16 a[172:173], v33 offset:2048
    buffer_load_dwordx4 v11, s[24:27], s61 offen nt lds
    v_mfma_f32_32x32x16_bf16 v[160:175], v[96:99], a[72:75], v[160:175]
    ds_read_b64_tr_b16 a[174:175], v33 offset:2560
    s_add_u32 m0, s53, 2048
    v_mfma_f32_32x32x16_bf16 v[176:191], v[96:99], a[76:79], v[176:191]
    v_mfma_f32_32x32x16_bf16 v[192:207], v[96:99], a[80:83], v[192:207]
    ds_read_b128 a[12:15], v29 offset:49152
    ds_read_b128 a[16:19], v29 offset:53248
    v_mfma_f32_32x32x16_bf16 v[208:223], v[100:103], a[72:75], v[208:223]
    s_waitcnt lgkmcnt(2)
    buffer_load_dwordx4 v10, s[24:27], s62 offen nt lds
    s_add_u32 m0, s53, 3072
    ds_read_b128 a[20:23], v29 offset:57344
    s_waitcnt vmcnt(13)
    ds_read_b64_tr_b16 a[176:177], v32 offset:4096
    v_mfma_f32_32x32x16_bf16 v[224:239], v[100:103], a[76:79], v[224:239]
    ds_read_b64_tr_b16 a[178:179], v32 offset:4608
    ds_read_b64_tr_b16 a[180:181], v33 offset:4096
    ds_read_b64_tr_b16 a[182:183], v33 offset:4608
    buffer_load_dwordx4 v11, s[24:27], s63 offen nt lds
    v_mfma_f32_32x32x16_bf16 v[240:255], v[100:103], a[80:83], v[240:255]
    s_add_u32 m0, s53, 3968
    v_mfma_f32_32x32x16_bf16 v[160:175], v[104:107], a[84:87], v[160:175]
    v_mfma_f32_32x32x16_bf16 v[176:191], v[104:107], a[88:91], v[176:191]
    s_waitcnt lgkmcnt(0)
    buffer_load_dwordx4 v10, s[24:27], s60 offen offset:128 nt lds
    s_add_u32 m0, s53, 4992
    s_waitcnt vmcnt(13)
    ds_read_b64_tr_b16 a[184:185], v32 offset:6144
    v_mfma_f32_32x32x16_bf16 v[192:207], v[104:107], a[92:95], v[192:207]
    ds_read_b64_tr_b16 a[186:187], v32 offset:6656
    ds_read_b128 a[24:27], v30 offset:49152
    ds_read_b64_tr_b16 a[188:189], v33 offset:6144
    buffer_load_dwordx4 v11, s[24:27], s61 offen offset:128 nt lds
    v_mfma_f32_32x32x16_bf16 v[208:223], v[108:111], a[84:87], v[208:223]
    ds_read_b128 a[28:31], v30 offset:53248
    ds_read_b64_tr_b16 a[190:191], v33 offset:6656
    s_add_u32 m0, s53, 6016
    ds_read_b128 a[32:35], v30 offset:57344
    v_mfma_f32_32x32x16_bf16 v[224:239], v[108:111], a[88:91], v[224:239]
    v_mfma_f32_32x32x16_bf16 v[240:255], v[108:111], a[92:95], v[240:255]
    s_waitcnt vmcnt(12)
    ds_read_b64_tr_b16 a[96:97], v32 offset:8192
    v_mfma_f32_32x32x16_bf16 v[160:175], a[128:131], a[0:3], v[160:175]
    s_waitcnt lgkmcnt(2)
    buffer_load_dwordx4 v10, s[24:27], s62 offen offset:128 nt lds
    s_add_u32 m0, s53, 7040
    ds_read_b64_tr_b16 a[98:99], v32 offset:8704
    ds_read_b64_tr_b16 a[100:101], v33 offset:8192
    v_mfma_f32_32x32x16_bf16 v[176:191], a[128:131], a[4:7], v[176:191]
    ds_read_b64_tr_b16 a[102:103], v33 offset:8704
    buffer_load_dwordx4 v11, s[24:27], s63 offen offset:128 nt lds
    s_add_u32 m0, s53, 7936
    v_mfma_f32_32x32x16_bf16 v[192:207], a[128:131], a[8:11], v[192:207]
    ds_read_b128 a[36:39], v31 offset:49152
    ds_read_b128 a[40:43], v31 offset:53248
    v_mfma_f32_32x32x16_bf16 v[208:223], a[132:135], a[0:3], v[208:223]
    ds_read_b128 a[44:47], v31 offset:57344
    v_mfma_f32_32x32x16_bf16 v[224:239], a[132:135], a[4:7], v[224:239]
    s_waitcnt lgkmcnt(3)
    buffer_load_dwordx4 v10, s[24:27], s60 offen offset:256 nt lds
    s_add_u32 m0, s53, 8960
    s_waitcnt vmcnt(13)
    ds_read_b64_tr_b16 a[104:105], v32 offset:10240
    v_mfma_f32_32x32x16_bf16 v[240:255], a[132:135], a[8:11], v[240:255]
    ds_read_b64_tr_b16 a[106:107], v32 offset:10752
    ds_read_b64_tr_b16 a[108:109], v33 offset:10240
    ds_read_b64_tr_b16 a[110:111], v33 offset:10752
    buffer_load_dwordx4 v11, s[24:27], s61 offen offset:256 nt lds
    v_mfma_f32_32x32x16_bf16 v[160:175], a[136:139], a[12:15], v[160:175]
    s_add_u32 m0, s53, 9984
    v_mfma_f32_32x32x16_bf16 v[176:191], a[136:139], a[16:19], v[176:191]
    v_mfma_f32_32x32x16_bf16 v[192:207], a[136:139], a[20:23], v[192:207]
    v_add_u32 v28, 61440, v28
    v_add_u32 v29, 61440, v29
    v_add_u32 v30, 61440, v30
    v_add_u32 v31, 61440, v31
    s_barrier
    ds_read_b128 a[48:51], v28 offset:0
    v_mfma_f32_32x32x16_bf16 v[208:223], a[140:143], a[12:15], v[208:223]
    s_waitcnt lgkmcnt(1)
    buffer_load_dwordx4 v10, s[24:27], s62 offen offset:256 nt lds
    s_add_u32 m0, s53, 11008
    ds_read_b128 a[52:55], v28 offset:4096
    buffer_load_dwordx4 v11, s[24:27], s63 offen offset:256 nt lds
    v_mfma_f32_32x32x16_bf16 v[224:239], a[140:143], a[16:19], v[224:239]
    s_waitcnt vmcnt(14)
    ds_read_b64_tr_b16 a[112:113], v32 offset:12288
    ds_read_b128 a[56:59], v28 offset:8192
    ds_read_b64_tr_b16 a[114:115], v32 offset:12800
    v_mfma_f32_32x32x16_bf16 v[240:255], a[140:143], a[20:23], v[240:255]
    ds_read_b64_tr_b16 a[116:117], v33 offset:12288
    ds_read_b64_tr_b16 a[118:119], v33 offset:12800
    s_add_u32 m0, s53, 11904
    v_mfma_f32_32x32x16_bf16 v[160:175], a[144:147], a[24:27], v[160:175]
    v_mfma_f32_32x32x16_bf16 v[176:191], a[144:147], a[28:31], v[176:191]
    s_waitcnt vmcnt(12)
    ds_read_b64_tr_b16 a[120:121], v32 offset:14336
    ds_read_b64_tr_b16 a[122:123], v32 offset:14848
    ds_read_b64_tr_b16 a[124:125], v33 offset:14336
    v_mfma_f32_32x32x16_bf16 v[192:207], a[144:147], a[32:35], v[192:207]
    s_waitcnt lgkmcnt(3)
    buffer_load_dwordx4 v10, s[24:27], s60 offen offset:384 nt lds
    s_add_u32 m0, s53, 12928
    ds_read_b128 a[60:63], v29 offset:0
    ds_read_b64_tr_b16 a[126:127], v33 offset:14848
    v_mfma_f32_32x32x16_bf16 v[208:223], a[148:151], a[24:27], v[208:223]
    buffer_load_dwordx4 v11, s[24:27], s61 offen offset:384 nt lds
    s_add_u32 m0, s53, 13952
    ds_read_b128 a[64:67], v29 offset:4096
    ds_read_b128 a[68:71], v29 offset:8192
    v_mfma_f32_32x32x16_bf16 v[224:239], a[148:151], a[28:31], v[224:239]
    v_mfma_f32_32x32x16_bf16 v[240:255], a[148:151], a[32:35], v[240:255]
    s_waitcnt lgkmcnt(2)
    buffer_load_dwordx4 v10, s[24:27], s62 offen offset:384 nt lds
    s_add_u32 m0, s53, 14976
    ds_read_b128 a[72:75], v30 offset:0
    ds_read_b128 a[76:79], v30 offset:4096
    v_mfma_f32_32x32x16_bf16 v[160:175], a[152:155], a[36:39], v[160:175]
    ds_read_b128 a[80:83], v30 offset:8192
    buffer_load_dwordx4 v11, s[24:27], s63 offen offset:384 nt lds
    v_mfma_f32_32x32x16_bf16 v[176:191], a[152:155], a[40:43], v[176:191]
    v_mfma_f32_32x32x16_bf16 v[192:207], a[152:155], a[44:47], v[192:207]
    ds_read_b128 a[84:87], v31 offset:0
    v_mfma_f32_32x32x16_bf16 v[208:223], a[156:159], a[36:39], v[208:223]
    ds_read_b128 a[88:91], v31 offset:4096
    ds_read_b128 a[92:95], v31 offset:8192
    v_mfma_f32_32x32x16_bf16 v[224:239], a[156:159], a[40:43], v[224:239]
    v_mfma_f32_32x32x16_bf16 v[240:255], a[156:159], a[44:47], v[240:255]
    s_barrier
    ds_read_b128 a[0:3], v28 offset:12288
    v_mfma_f32_32x32x16_bf16 v[160:175], a[160:163], a[48:51], v[160:175]
    ds_read_b128 a[4:7], v28 offset:16384
    ds_read_b128 a[8:11], v28 offset:20480
    v_mfma_f32_32x32x16_bf16 v[176:191], a[160:163], a[52:55], v[176:191]
    v_mfma_f32_32x32x16_bf16 v[192:207], a[160:163], a[56:59], v[192:207]
    v_mfma_f32_32x32x16_bf16 v[208:223], a[164:167], a[48:51], v[208:223]
    ds_read_b128 a[12:15], v29 offset:12288
    ds_read_b128 a[16:19], v29 offset:16384
    v_mfma_f32_32x32x16_bf16 v[224:239], a[164:167], a[52:55], v[224:239]
    ds_read_b128 a[20:23], v29 offset:20480
    v_mfma_f32_32x32x16_bf16 v[240:255], a[164:167], a[56:59], v[240:255]
    v_mfma_f32_32x32x16_bf16 v[160:175], a[168:171], a[60:63], v[160:175]
    ds_read_b128 a[24:27], v30 offset:12288
    s_waitcnt lgkmcnt(4)
    v_mfma_f32_32x32x16_bf16 v[176:191], a[168:171], a[64:67], v[176:191]
    ds_read_b128 a[28:31], v30 offset:16384
    s_add_u32 s60, s60, 65536
    s_add_u32 s61, s61, 65536
    s_add_u32 s62, s62, 65536
    s_add_u32 s63, s63, 65536
    s_add_u32 m0, s53, 0
    v_mfma_f32_32x32x16_bf16 v[192:207], a[168:171], a[68:71], v[192:207]
    s_waitcnt vmcnt(12)
    ds_read_b128 a[192:195], v2 offset:0
    ds_read_b128 a[32:35], v30 offset:20480
    ds_read_b128 a[196:199], v3 offset:0
    v_mfma_f32_32x32x16_bf16 v[208:223], a[172:175], a[60:63], v[208:223]
    ds_read_b128 a[200:203], v4 offset:0
    ds_read_b128 a[204:207], v5 offset:0
    ds_read_b128 a[36:39], v31 offset:12288
    v_mfma_f32_32x32x16_bf16 v[224:239], a[172:175], a[64:67], v[224:239]
    s_waitcnt vmcnt(8)
    ds_read_b128 a[208:211], v2 offset:4096
    ds_read_b128 a[40:43], v31 offset:16384
    ds_read_b128 a[212:215], v3 offset:4096
    v_mfma_f32_32x32x16_bf16 v[240:255], a[172:175], a[68:71], v[240:255]
    ds_read_b128 a[44:47], v31 offset:20480
    ds_read_b128 a[216:219], v4 offset:4096
    ds_read_b128 a[220:223], v5 offset:4096
    v_mfma_f32_32x32x16_bf16 v[160:175], a[176:179], a[72:75], v[160:175]
    v_mfma_f32_32x32x16_bf16 v[176:191], a[176:179], a[76:79], v[176:191]
    v_mfma_f32_32x32x16_bf16 v[192:207], a[176:179], a[80:83], v[192:207]
    v_mfma_f32_32x32x16_bf16 v[208:223], a[180:183], a[72:75], v[208:223]
    v_mfma_f32_32x32x16_bf16 v[224:239], a[180:183], a[76:79], v[224:239]
    s_waitcnt lgkmcnt(5)
    buffer_load_dwordx4 v10, s[24:27], s60 offen nt lds
    s_add_u32 m0, s53, 1024
    v_mfma_f32_32x32x16_bf16 v[240:255], a[180:183], a[80:83], v[240:255]
    buffer_load_dwordx4 v11, s[24:27], s61 offen nt lds
    s_add_u32 m0, s53, 2048
    v_mfma_f32_32x32x16_bf16 v[160:175], a[184:187], a[84:87], v[160:175]
    buffer_load_dwordx4 v10, s[24:27], s62 offen nt lds
    s_add_u32 m0, s53, 3072
    v_mfma_f32_32x32x16_bf16 v[176:191], a[184:187], a[88:91], v[176:191]
    buffer_load_dwordx4 v11, s[24:27], s63 offen nt lds
    s_add_u32 m0, s53, 3968
    v_mfma_f32_32x32x16_bf16 v[192:207], a[184:187], a[92:95], v[192:207]
    s_waitcnt lgkmcnt(0)
    buffer_load_dwordx4 v10, s[24:27], s60 offen offset:128 nt lds
    s_add_u32 m0, s53, 4992
    v_mfma_f32_32x32x16_bf16 v[208:223], a[188:191], a[84:87], v[208:223]
    buffer_load_dwordx4 v11, s[24:27], s61 offen offset:128 nt lds
    s_add_u32 m0, s53, 6016
    v_mfma_f32_32x32x16_bf16 v[224:239], a[188:191], a[88:91], v[224:239]
    buffer_load_dwordx4 v10, s[24:27], s62 offen offset:128 nt lds
    s_add_u32 m0, s53, 7040
    v_mfma_f32_32x32x16_bf16 v[240:255], a[188:191], a[92:95], v[240:255]
    buffer_load_dwordx4 v11, s[24:27], s63 offen offset:128 nt lds
    s_add_u32 m0, s53, 7936
    v_mfma_f32_32x32x16_bf16 v[160:175], a[96:99], a[0:3], v[160:175]
    v_mfma_f32_32x32x16_bf16 v[160:175], a[104:107], a[12:15], v[160:175]
    v_mfma_f32_32x32x16_bf16 v[160:175], a[112:115], a[24:27], v[160:175]
    v_mfma_f32_32x32x16_bf16 v[160:175], a[120:123], a[36:39], v[160:175]
    v_mfma_f32_32x32x16_bf16 v[176:191], a[96:99], a[4:7], v[176:191]
    v_mfma_f32_32x32x16_bf16 v[176:191], a[104:107], a[16:19], v[176:191]
    s_waitcnt vmcnt(12)
    ds_read_b128 a[224:227], v2 offset:8192
    ds_read_b128 a[228:231], v3 offset:8192
    v_mfma_f32_32x32x16_bf16 v[176:191], a[112:115], a[28:31], v[176:191]
    v_mfma_f32_32x32x16_bf16 v[176:191], a[120:123], a[40:43], v[176:191]
    ds_read_b128 a[232:235], v4 offset:8192
    s_nop 3
    v_cvt_pk_bf16_f32 v112, v160, v161
    v_cvt_pk_bf16_f32 v113, v162, v163
    v_cvt_pk_bf16_f32 v114, v164, v165
    v_cvt_pk_bf16_f32 v115, v166, v167
    v_mfma_f32_32x32x16_bf16 v[192:207], a[96:99], a[8:11], v[192:207]
    ds_write_b128 v39, v[112:115] offset:0
    ds_read_b128 a[236:239], v5 offset:8192
    v_mfma_f32_32x32x16_bf16 v[192:207], a[104:107], a[20:23], v[192:207]
    s_waitcnt vmcnt(8)
    ds_read_b128 a[240:243], v2 offset:12288
    v_cvt_pk_bf16_f32 v116, v168, v169
    v_cvt_pk_bf16_f32 v117, v170, v171
    v_cvt_pk_bf16_f32 v118, v172, v173
    v_cvt_pk_bf16_f32 v119, v174, v175
    v_mfma_f32_32x32x16_bf16 v[192:207], a[112:115], a[32:35], v[192:207]
    ds_write_b128 v39, v[116:119] offset:1024
    ds_read_b128 a[244:247], v3 offset:12288
    v_cvt_pk_bf16_f32 v120, v176, v177
    v_mfma_f32_32x32x16_bf16 v[192:207], a[120:123], a[44:47], v[192:207]
    ds_read_b128 a[248:251], v4 offset:12288
    ds_read_b128 a[252:255], v5 offset:12288
    v_cvt_pk_bf16_f32 v121, v178, v179
    v_cvt_pk_bf16_f32 v122, v180, v181
    v_cvt_pk_bf16_f32 v123, v182, v183
    v_mfma_f32_32x32x16_bf16 v[208:223], a[100:103], a[0:3], v[208:223]
    ds_write_b128 v39, v[120:123] offset:4096
    v_cvt_pk_bf16_f32 v124, v184, v185
    v_cvt_pk_bf16_f32 v125, v186, v187
    v_cvt_pk_bf16_f32 v126, v188, v189
    v_mfma_f32_32x32x16_bf16 v[208:223], a[108:111], a[12:15], v[208:223]
    v_cvt_pk_bf16_f32 v127, v190, v191
    ds_write_b128 v39, v[124:127] offset:5120
    v_mfma_f32_32x32x16_bf16 v[208:223], a[116:119], a[24:27], v[208:223]
    s_waitcnt lgkmcnt(7)
    buffer_load_dwordx4 v10, s[24:27], s60 offen offset:256 nt lds
    s_add_u32 m0, s53, 8960
    v_cvt_pk_bf16_f32 v128, v192, v193
    v_cvt_pk_bf16_f32 v129, v194, v195
    v_cvt_pk_bf16_f32 v130, v196, v197
    v_cvt_pk_bf16_f32 v131, v198, v199
    v_mfma_f32_32x32x16_bf16 v[208:223], a[124:127], a[36:39], v[208:223]
    ds_write_b128 v39, v[128:131] offset:8192
    buffer_load_dwordx4 v11, s[24:27], s61 offen offset:256 nt lds
    s_add_u32 m0, s53, 9984
    v_cvt_pk_bf16_f32 v132, v200, v201
    v_mfma_f32_32x32x16_bf16 v[224:239], a[100:103], a[4:7], v[224:239]
    buffer_load_dwordx4 v10, s[24:27], s62 offen offset:256 nt lds
    v_cvt_pk_bf16_f32 v133, v202, v203
    v_cvt_pk_bf16_f32 v134, v204, v205
    s_add_u32 m0, s53, 11008
    v_cvt_pk_bf16_f32 v135, v206, v207
    v_mfma_f32_32x32x16_bf16 v[224:239], a[108:111], a[16:19], v[224:239]
    ds_write_b128 v39, v[132:135] offset:9216
    buffer_load_dwordx4 v11, s[24:27], s63 offen offset:256 nt lds
    s_add_u32 m0, s53, 11904
    v_mfma_f32_32x32x16_bf16 v[224:239], a[116:119], a[28:31], v[224:239]
    s_waitcnt lgkmcnt(3)
    buffer_load_dwordx4 v10, s[24:27], s60 offen offset:384 nt lds
    s_add_u32 m0, s53, 12928
    v_cvt_pk_bf16_f32 v136, v208, v209
    v_cvt_pk_bf16_f32 v137, v210, v211
    v_cvt_pk_bf16_f32 v138, v212, v213
    v_cvt_pk_bf16_f32 v139, v214, v215
    v_mfma_f32_32x32x16_bf16 v[224:239], a[124:127], a[40:43], v[224:239]
    ds_write_b128 v39, v[136:139] offset:2048
    buffer_load_dwordx4 v11, s[24:27], s61 offen offset:384 nt lds
    s_add_u32 m0, s53, 13952
    v_cvt_pk_bf16_f32 v140, v216, v217
    v_mfma_f32_32x32x16_bf16 v[240:255], a[100:103], a[8:11], v[240:255]
    buffer_load_dwordx4 v10, s[24:27], s62 offen offset:384 nt lds
    v_cvt_pk_bf16_f32 v141, v218, v219
    v_cvt_pk_bf16_f32 v142, v220, v221
    s_add_u32 m0, s53, 14976
    v_cvt_pk_bf16_f32 v143, v222, v223
    v_mfma_f32_32x32x16_bf16 v[240:255], a[108:111], a[20:23], v[240:255]
    ds_write_b128 v39, v[140:143] offset:3072
    buffer_load_dwordx4 v11, s[24:27], s63 offen offset:384 nt lds
    v_mfma_f32_32x32x16_bf16 v[240:255], a[116:119], a[32:35], v[240:255]
    s_add_u32 s60, s60, 65536
    s_add_u32 s61, s61, 65536
    s_add_u32 s62, s62, 65536
    s_add_u32 s63, s63, 65536
    v_cvt_pk_bf16_f32 v144, v224, v225
    v_cvt_pk_bf16_f32 v145, v226, v227
    v_cvt_pk_bf16_f32 v146, v228, v229
    v_mfma_f32_32x32x16_bf16 v[240:255], a[124:127], a[44:47], v[240:255]
    v_cvt_pk_bf16_f32 v147, v230, v231
    ds_write_b128 v39, v[144:147] offset:6144
    v_cvt_pk_bf16_f32 v148, v232, v233
    v_cvt_pk_bf16_f32 v149, v234, v235
    v_cvt_pk_bf16_f32 v150, v236, v237
    v_cvt_pk_bf16_f32 v151, v238, v239
    ds_write_b128 v39, v[148:151] offset:7168
    s_nop 4
    v_cvt_pk_bf16_f32 v152, v240, v241
    v_cvt_pk_bf16_f32 v153, v242, v243
    v_cvt_pk_bf16_f32 v154, v244, v245
    v_cvt_pk_bf16_f32 v155, v246, v247
    ds_write_b128 v39, v[152:155] offset:10240
    v_cvt_pk_bf16_f32 v156, v248, v249
    v_cvt_pk_bf16_f32 v157, v250, v251
    v_cvt_pk_bf16_f32 v158, v252, v253
    v_cvt_pk_bf16_f32 v159, v254, v255
    ds_write_b128 v39, v[156:159] offset:11264
    s_waitcnt lgkmcnt(0)
    s_barrier
    ds_read_b128 a[0:3], v38 offset:0
    ds_read_b128 a[4:7], v38 offset:1024
    ds_read_b128 a[8:11], v38 offset:2048
    ds_read_b128 a[12:15], v38 offset:3072
    ds_read_b128 a[16:19], v38 offset:16384
    ds_read_b128 a[20:23], v38 offset:17408
    ds_read_b128 a[24:27], v38 offset:18432
    s_waitcnt lgkmcnt(6)
    v_mfma_f32_32x32x16_bf16 v[112:127], a[192:195], a[0:3], 0
    ds_read_b128 a[28:31], v38 offset:19456
    ds_read_b128 a[32:35], v38 offset:32768
    v_min_u32 v27, 27, v1
    v_lshlrev_b32 v27, 7, v27
    s_waitcnt lgkmcnt(7)
    v_mfma_f32_32x32x16_bf16 v[112:127], a[196:199], a[4:7], v[112:127]
    s_lshl_b32 s49, s45, 2
    s_add_u32 s49, s49, s48
    s_mul_i32 s49, s49, 3584
    buffer_load_dword v0, v27, s[36:39], s49 offen
    ds_read_b128 a[36:39], v38 offset:33792
    s_waitcnt lgkmcnt(7)
    v_mfma_f32_32x32x16_bf16 v[112:127], a[200:203], a[8:11], v[112:127]
    s_lshl_b32 s49, s45, 4
    s_add_u32 s49, s49, s46
    s_lshl_b32 s49, s49, 11
    s_add_u32 s49, s49, 23068672
    v_min_u32 v26, 9, v1
    v_lshl_add_u32 v26, v26, 7, s49
    s_waitcnt lgkmcnt(6)
    v_mfma_f32_32x32x16_bf16 v[112:127], a[204:207], a[12:15], v[112:127]
    global_load_dword v0, v26, s[16:17] sc1
    ds_read_b128 a[40:43], v38 offset:34816
    ds_read_b128 a[44:47], v38 offset:35840
    v_mov_b32 v64, 0
    s_waitcnt lgkmcnt(7)
    v_mfma_f32_32x32x16_bf16 v[112:127], a[208:211], a[16:19], v[112:127]
    ds_read_b128 a[48:51], v38 offset:49152
    ds_read_b128 a[52:55], v38 offset:50176
    v_mov_b32 v65, 0
    v_mov_b32 v66, 0
    s_waitcnt lgkmcnt(7)
    v_mfma_f32_32x32x16_bf16 v[112:127], a[212:215], a[20:23], v[112:127]
    ds_read_b128 a[56:59], v38 offset:51200
    ds_read_b128 a[60:63], v38 offset:52224
    ds_read_b128 a[64:67], v38 offset:4096
    v_mov_b32 v67, 0
    v_mfma_f32_32x32x16_bf16 v[112:127], a[216:219], a[24:27], v[112:127]
    ds_read_b128 a[68:71], v38 offset:5120
    ds_read_b128 a[72:75], v38 offset:6144
    ds_read_b128 a[76:79], v38 offset:7168
    s_waitcnt lgkmcnt(10)
    v_mfma_f32_32x32x16_bf16 v[112:127], a[220:223], a[28:31], v[112:127]
    ds_read_b128 a[80:83], v38 offset:20480
    ds_read_b128 a[84:87], v38 offset:21504
    ds_read_b128 a[88:91], v38 offset:22528
    v_mfma_f32_32x32x16_bf16 v[112:127], a[224:227], a[32:35], v[112:127]
    ds_read_b128 a[92:95], v38 offset:23552
    ds_read_b128 a[96:99], v38 offset:36864
    ds_read_b128 a[100:103], v38 offset:37888
    v_mfma_f32_32x32x16_bf16 v[112:127], a[228:231], a[36:39], v[112:127]
    ds_read_b128 a[104:107], v38 offset:38912
    ds_read_b128 a[108:111], v38 offset:39936
    ds_read_b128 a[112:115], v38 offset:53248
    s_waitcnt lgkmcnt(15)
    v_mfma_f32_32x32x16_bf16 v[112:127], a[232:235], a[40:43], v[112:127]
    ds_read_b128 a[116:119], v38 offset:54272
    ds_read_b128 a[120:123], v38 offset:55296
    ds_read_b128 a[124:127], v38 offset:56320
    v_mfma_f32_32x32x16_bf16 v[112:127], a[236:239], a[44:47], v[112:127]
    ds_read_b128 a[128:131], v38 offset:8192
    ds_read_b128 a[132:135], v38 offset:9216
    ds_read_b128 a[136:139], v38 offset:10240
    v_mfma_f32_32x32x16_bf16 v[112:127], a[240:243], a[48:51], v[112:127]
    ds_read_b128 a[140:143], v38 offset:11264
    ds_read_b128 a[144:147], v38 offset:24576
    ds_read_b128 a[148:151], v38 offset:25600
    v_mfma_f32_32x32x16_bf16 v[112:127], a[244:247], a[52:55], v[112:127]
    ds_read_b128 a[152:155], v38 offset:26624
    ds_read_b128 a[156:159], v38 offset:27648
    ds_read_b128 a[160:163], v38 offset:40960
    s_waitcnt lgkmcnt(15)
    v_mfma_f32_32x32x16_bf16 v[112:127], a[248:251], a[56:59], v[112:127]
    ds_read_b128 a[164:167], v38 offset:41984
    ds_read_b128 a[168:171], v38 offset:43008
    ds_read_b128 a[172:175], v38 offset:44032
    v_mfma_f32_32x32x16_bf16 v[112:127], a[252:255], a[60:63], v[112:127]
    ds_read_b128 a[176:179], v38 offset:57344
    ds_read_b128 a[180:183], v38 offset:58368
    ds_read_b128 a[184:187], v38 offset:59392
    v_mfma_f32_32x32x16_bf16 v[128:143], a[192:195], a[64:67], 0
    ds_read_b128 a[188:191], v38 offset:60416
    v_mfma_f32_32x32x16_bf16 v[128:143], a[196:199], a[68:71], v[128:143]
    v_mfma_f32_32x32x16_bf16 v[128:143], a[200:203], a[72:75], v[128:143]
    s_nop 4
    v_max3_f32 v43, v112, v113, v114
    v_mfma_f32_32x32x16_bf16 v[128:143], a[204:207], a[76:79], v[128:143]
    s_waitcnt lgkmcnt(0)
    s_barrier
    s_add_u32 m0, s54, 0
    s_add_u32 s56, s56, 4096
    buffer_load_dwordx4 v12, s[28:31], s56 offen nt lds
    s_add_u32 m0, s54, 1024
    v_max3_f32 v43, v43, v115, v116
    v_mfma_f32_32x32x16_bf16 v[128:143], a[208:211], a[80:83], v[128:143]
    s_add_u32 s56, s56, 4096
    v_max3_f32 v43, v43, v117, v118
    v_max3_f32 v43, v43, v119, v120
    buffer_load_dwordx4 v12, s[28:31], s56 offen nt lds
    s_add_u32 m0, s54, 2048
    v_mfma_f32_32x32x16_bf16 v[128:143], a[212:215], a[84:87], v[128:143]
    s_add_u32 s56, s56, 4096
    v_max3_f32 v43, v43, v121, v122
    v_max3_f32 v43, v43, v123, v124
    v_max3_f32 v43, v43, v125, v126
    v_max_f32 v43, v43, v127
    v_mfma_f32_32x32x16_bf16 v[128:143], a[216:219], a[88:91], v[128:143]
    buffer_load_dwordx4 v12, s[28:31], s56 offen nt lds
    v_mov_b32 v44, v43
    s_nop 1
    v_permlane32_swap_b32 v43, v44
    s_add_u32 m0, s54, 3072
    v_max_f32 v43, v43, v44
    ds_write_b32 v41, v43 offset:0
    v_mfma_f32_32x32x16_bf16 v[128:143], a[220:223], a[92:95], v[128:143]
    s_add_u32 s56, s56, 4096
    buffer_load_dwordx4 v12, s[28:31], s56 offen nt lds
    s_add_u32 m0, s54, 4096
    s_add_u32 s56, s56, 4096
    buffer_load_dwordx4 v12, s[28:31], s56 offen nt lds
    s_add_u32 m0, s54, 5120
    v_mfma_f32_32x32x16_bf16 v[128:143], a[224:227], a[96:99], v[128:143]
    s_waitcnt lgkmcnt(0)
    s_barrier
    ds_read_b128 v[28:31], v40 offset:0
    s_add_u32 s56, s56, 4096
    buffer_load_dwordx4 v12, s[28:31], s56 offen nt lds
    s_add_u32 m0, s54, 6144
    v_mfma_f32_32x32x16_bf16 v[128:143], a[228:231], a[100:103], v[128:143]
    s_add_u32 s56, s56, 4096
    buffer_load_dwordx4 v12, s[28:31], s56 offen nt lds
    s_add_u32 m0, s54, 7168
    v_mfma_f32_32x32x16_bf16 v[128:143], a[232:235], a[104:107], v[128:143]
    s_add_u32 s56, s56, 4096
    buffer_load_dwordx4 v12, s[28:31], s56 offen nt lds
    s_add_u32 m0, s54, 8192
    v_mfma_f32_32x32x16_bf16 v[128:143], a[236:239], a[108:111], v[128:143]
    s_add_u32 s56, s56, 4096
    s_waitcnt lgkmcnt(0)
    v_max3_f32 v42, v28, v29, v30
    v_max_f32 v42, v42, v31
    v_mul_f32 v13, s50, v42
    v_sub_f32 v13, 0, v13
    v_fma_f32 v112, v112, s50, v13
    v_fma_f32 v113, v113, s50, v13
    v_mfma_f32_32x32x16_bf16 v[128:143], a[240:243], a[112:115], v[128:143]
    buffer_load_dwordx4 v12, s[28:31], s56 offen nt lds
    v_fma_f32 v114, v114, s50, v13
    v_fma_f32 v115, v115, s50, v13
    s_add_u32 m0, s54, 9216
    v_fma_f32 v116, v116, s50, v13
    v_fma_f32 v117, v117, s50, v13
    v_fma_f32 v118, v118, s50, v13
    v_mfma_f32_32x32x16_bf16 v[128:143], a[244:247], a[116:119], v[128:143]
    s_add_u32 s56, s56, 4096
    v_fma_f32 v119, v119, s50, v13
    v_fma_f32 v120, v120, s50, v13
    v_fma_f32 v121, v121, s50, v13
    buffer_load_dwordx4 v12, s[28:31], s56 offen nt lds
    s_add_u32 m0, s54, 10240
    v_fma_f32 v122, v122, s50, v13
    v_mfma_f32_32x32x16_bf16 v[128:143], a[248:251], a[120:123], v[128:143]
    s_add_u32 s56, s56, 4096
    v_fma_f32 v123, v123, s50, v13
    v_fma_f32 v124, v124, s50, v13
    v_fma_f32 v125, v125, s50, v13
    v_fma_f32 v126, v126, s50, v13
    v_fma_f32 v127, v127, s50, v13
    buffer_load_dwordx4 v12, s[28:31], s56 offen nt lds
    v_mfma_f32_32x32x16_bf16 v[128:143], a[252:255], a[124:127], v[128:143]
    s_add_u32 m0, s54, 11264
    v_exp_f32 v22, v112
    v_exp_f32 v23, v113
    v_exp_f32 v24, v114
    v_mfma_f32_32x32x16_bf16 v[144:159], a[192:195], a[128:131], 0
    s_add_u32 s56, s56, 4096
    buffer_load_dwordx4 v12, s[28:31], s56 offen nt lds
    s_add_u32 m0, s54, 12288
    v_exp_f32 v25, v115
    v_add_f32 v19, v22, v23
    v_cvt_pk_bf16_f32 v88, v22, v23
    v_mfma_f32_32x32x16_bf16 v[144:159], a[196:199], a[132:135], v[144:159]
    s_add_u32 s56, s56, 4096
    v_exp_f32 v26, v116
    buffer_load_dwordx4 v12, s[28:31], s56 offen nt lds
    s_add_u32 m0, s54, 13312
    v_exp_f32 v27, v117
    v_mfma_f32_32x32x16_bf16 v[144:159], a[200:203], a[136:139], v[144:159]
    s_add_u32 s56, s56, 4096
    v_add_f32 v19, v19, v24
    v_cvt_pk_bf16_f32 v89, v24, v25
    v_add_f32 v19, v19, v25
    buffer_load_dwordx4 v12, s[28:31], s56 offen nt lds
    s_add_u32 m0, s54, 14336
    v_max3_f32 v43, v128, v129, v130
    v_mfma_f32_32x32x16_bf16 v[144:159], a[204:207], a[140:143], v[144:159]
    s_add_u32 s56, s56, 4096
    v_exp_f32 v22, v118
    v_exp_f32 v23, v119
    v_add_f32 v19, v19, v26
    v_max3_f32 v43, v43, v131, v132
    v_mfma_f32_32x32x16_bf16 v[144:159], a[208:211], a[144:147], v[144:159]
    buffer_load_dwordx4 v12, s[28:31], s56 offen nt lds
    v_cvt_pk_bf16_f32 v90, v26, v27
    s_add_u32 m0, s54, 15360
    v_max3_f32 v43, v43, v133, v134
    v_add_f32 v19, v19, v27
    v_max3_f32 v43, v43, v135, v136
    v_max3_f32 v43, v43, v137, v138
    v_mfma_f32_32x32x16_bf16 v[144:159], a[212:215], a[148:151], v[144:159]
    s_add_u32 s56, s56, 4096
    v_exp_f32 v24, v120
    v_max3_f32 v43, v43, v139, v140
    v_exp_f32 v25, v121
    v_max3_f32 v43, v43, v141, v142
    v_mfma_f32_32x32x16_bf16 v[144:159], a[216:219], a[152:155], v[144:159]
    buffer_load_dwordx4 v12, s[28:31], s56 offen nt lds
    v_max_f32 v43, v43, v143
    v_add_f32 v19, v19, v22
    v_mov_b32 v44, v43
    v_cvt_pk_bf16_f32 v91, v22, v23
    s_nop 0
    v_permlane32_swap_b32 v43, v44
    v_mfma_f32_32x32x16_bf16 v[144:159], a[220:223], a[156:159], v[144:159]
    v_max_f32 v43, v43, v44
    v_add_f32 v19, v19, v23
    ds_write_b32 v41, v43 offset:512
    v_exp_f32 v26, v122
    v_mfma_f32_32x32x16_bf16 v[144:159], a[224:227], a[160:163], v[144:159]
    s_waitcnt lgkmcnt(0)
    s_barrier
    v_exp_f32 v27, v123
    v_add_f32 v19, v19, v24
    v_cvt_pk_bf16_f32 v92, v24, v25
    v_add_f32 v19, v19, v25
    v_mfma_f32_32x32x16_bf16 v[144:159], a[228:231], a[164:167], v[144:159]
    ds_read_b128 v[32:35], v40 offset:512
    v_exp_f32 v22, v124
    v_exp_f32 v23, v125
    v_add_f32 v19, v19, v26
    v_mfma_f32_32x32x16_bf16 v[144:159], a[232:235], a[168:171], v[144:159]
    v_cvt_pk_bf16_f32 v93, v26, v27
    v_add_f32 v19, v19, v27
    v_exp_f32 v24, v126
    v_exp_f32 v25, v127
    v_mfma_f32_32x32x16_bf16 v[144:159], a[236:239], a[172:175], v[144:159]
    v_add_f32 v19, v19, v22
    v_cvt_pk_bf16_f32 v94, v22, v23
    v_add_f32 v19, v19, v23
    v_add_f32 v19, v19, v24
    v_cvt_pk_bf16_f32 v95, v24, v25
    v_mfma_f32_32x32x16_bf16 v[144:159], a[240:243], a[176:179], v[144:159]
    v_add_f32 v19, v19, v25
    v_mov_b32 v16, v19
    s_waitcnt lgkmcnt(0)
    v_max3_f32 v42, v32, v33, v34
    v_max_f32 v42, v42, v35
    v_mul_f32 v14, s50, v42
    v_mfma_f32_32x32x16_bf16 v[144:159], a[244:247], a[180:183], v[144:159]
    v_sub_f32 v14, 0, v14
    v_fma_f32 v128, v128, s50, v14
    v_fma_f32 v129, v129, s50, v14
    v_fma_f32 v130, v130, s50, v14
    v_fma_f32 v131, v131, s50, v14
    v_fma_f32 v132, v132, s50, v14
    v_mfma_f32_32x32x16_bf16 v[144:159], a[248:251], a[184:187], v[144:159]
    v_fma_f32 v133, v133, s50, v14
    v_fma_f32 v134, v134, s50, v14
    v_fma_f32 v135, v135, s50, v14
    v_fma_f32 v136, v136, s50, v14
    v_fma_f32 v137, v137, s50, v14
    v_fma_f32 v138, v138, s50, v14
    v_mfma_f32_32x32x16_bf16 v[144:159], a[252:255], a[188:191], v[144:159]
    v_mfma_f32_32x32x16_bf16 v[160:175], v[64:67], v[64:67], 0
    v_fma_f32 v139, v139, s50, v14
    v_fma_f32 v140, v140, s50, v14
    v_fma_f32 v141, v141, s50, v14
    v_fma_f32 v142, v142, s50, v14
    v_fma_f32 v143, v143, s50, v14
    v_exp_f32 v22, v128
    v_exp_f32 v23, v129
    v_exp_f32 v24, v130
    v_exp_f32 v25, v131
    v_add_f32 v20, v22, v23
    v_cvt_pk_bf16_f32 v96, v22, v23
    v_exp_f32 v26, v132
    v_exp_f32 v27, v133
    v_add_f32 v20, v20, v24
    v_cvt_pk_bf16_f32 v97, v24, v25
    v_add_f32 v20, v20, v25
    v_exp_f32 v22, v134
    v_exp_f32 v23, v135
    v_mfma_f32_32x32x16_bf16 v[176:191], v[64:67], v[64:67], 0
    v_add_f32 v20, v20, v26
    v_max3_f32 v43, v144, v145, v146
    v_cvt_pk_bf16_f32 v98, v26, v27
    v_max3_f32 v43, v43, v147, v148
    v_add_f32 v20, v20, v27
    v_max3_f32 v43, v43, v149, v150
    v_exp_f32 v24, v136
    v_max3_f32 v43, v43, v151, v152
    v_max3_f32 v43, v43, v153, v154
    v_exp_f32 v25, v137
    v_mfma_f32_32x32x16_bf16 v[192:207], v[64:67], v[64:67], 0
    v_max3_f32 v43, v43, v155, v156
    v_max3_f32 v43, v43, v157, v158
    v_add_f32 v20, v20, v22
    v_max_f32 v43, v43, v159
    v_cvt_pk_bf16_f32 v99, v22, v23
    v_mov_b32 v44, v43
    v_add_f32 v20, v20, v23
    s_nop 0
    v_permlane32_swap_b32 v43, v44
    v_exp_f32 v26, v138
    v_max_f32 v43, v43, v44
    v_mfma_f32_32x32x16_bf16 v[208:223], v[64:67], v[64:67], 0
    ds_write_b32 v41, v43 offset:1024
    v_exp_f32 v27, v139
    v_add_f32 v20, v20, v24
    v_cvt_pk_bf16_f32 v100, v24, v25
    v_add_f32 v20, v20, v25
    v_mfma_f32_32x32x16_bf16 v[224:239], v[64:67], v[64:67], 0
    v_exp_f32 v22, v140
    v_exp_f32 v23, v141
    v_add_f32 v20, v20, v26
    v_mfma_f32_32x32x16_bf16 v[240:255], v[64:67], v[64:67], 0
    v_cvt_pk_bf16_f32 v101, v26, v27
    s_waitcnt lgkmcnt(0)
    s_barrier
    ds_read_b128 v[36:39], v40 offset:1024
    v_add_f32 v20, v20, v27
    v_exp_f32 v24, v142
    v_exp_f32 v25, v143
    v_add_f32 v20, v20, v22
    v_cvt_pk_bf16_f32 v102, v22, v23
    v_add_f32 v20, v20, v23
    v_add_f32 v20, v20, v24
    v_cvt_pk_bf16_f32 v103, v24, v25
    v_add_f32 v20, v20, v25
    v_mov_b32 v17, v20
    s_waitcnt lgkmcnt(0)
    v_max3_f32 v42, v36, v37, v38
    v_max_f32 v42, v42, v39
    v_mul_f32 v15, s50, v42
    v_sub_f32 v15, 0, v15
    v_fma_f32 v144, v144, s50, v15
    v_fma_f32 v145, v145, s50, v15
    v_fma_f32 v146, v146, s50, v15
    v_fma_f32 v147, v147, s50, v15
    v_fma_f32 v148, v148, s50, v15
    v_fma_f32 v149, v149, s50, v15
    v_fma_f32 v150, v150, s50, v15
    v_fma_f32 v151, v151, s50, v15
    v_fma_f32 v152, v152, s50, v15
    v_fma_f32 v153, v153, s50, v15
    v_fma_f32 v154, v154, s50, v15
    v_fma_f32 v155, v155, s50, v15
    v_fma_f32 v156, v156, s50, v15
    v_fma_f32 v157, v157, s50, v15
    v_fma_f32 v158, v158, s50, v15
    v_fma_f32 v159, v159, s50, v15
    s_waitcnt vmcnt(30)
    ds_read_b128 a[192:195], v2 offset:0
    v_exp_f32 v22, v144
    v_exp_f32 v23, v145
    v_exp_f32 v24, v146
    ds_read_b128 a[196:199], v3 offset:0
    v_exp_f32 v25, v147
    v_add_f32 v21, v22, v23
    v_cvt_pk_bf16_f32 v104, v22, v23
    ds_read_b128 a[200:203], v4 offset:0
    v_exp_f32 v26, v148
    v_exp_f32 v27, v149
    ds_read_b128 a[204:207], v5 offset:0
    v_add_f32 v21, v21, v24
    v_cvt_pk_bf16_f32 v105, v24, v25
    v_add_f32 v21, v21, v25
    v_exp_f32 v22, v150
    s_waitcnt vmcnt(26)
    ds_read_b128 a[208:211], v2 offset:4096
    v_exp_f32 v23, v151
    v_add_f32 v21, v21, v26
    v_cvt_pk_bf16_f32 v106, v26, v27
    v_add_f32 v21, v21, v27
    ds_read_b128 a[212:215], v3 offset:4096
    v_exp_f32 v24, v152
    v_exp_f32 v25, v153
    ds_read_b128 a[216:219], v4 offset:4096
    v_add_f32 v21, v21, v22
    v_cvt_pk_bf16_f32 v107, v22, v23
    v_add_f32 v21, v21, v23
    v_exp_f32 v26, v154
    ds_read_b128 a[220:223], v5 offset:4096
    v_exp_f32 v27, v155
    v_add_f32 v21, v21, v24
    v_cvt_pk_bf16_f32 v108, v24, v25
    v_add_f32 v21, v21, v25
    s_waitcnt vmcnt(22)
    ds_read_b128 a[224:227], v2 offset:8192
    v_exp_f32 v22, v156
    v_exp_f32 v23, v157
    ds_read_b128 a[228:231], v3 offset:8192
    v_add_f32 v21, v21, v26
    v_cvt_pk_bf16_f32 v109, v26, v27
    v_add_f32 v21, v21, v27
    v_exp_f32 v24, v158
    ds_read_b128 a[232:235], v4 offset:8192
    v_exp_f32 v25, v159
    v_add_f32 v21, v21, v22
    v_cvt_pk_bf16_f32 v110, v22, v23
    v_add_f32 v21, v21, v23
    ds_read_b128 a[236:239], v5 offset:8192
    s_mov_b32 s51, 1
    v_add_f32 v21, v21, v24
    v_cvt_pk_bf16_f32 v111, v24, v25
    v_add_f32 v21, v21, v25
    v_mov_b32 v18, v21
L_loop:
    s_waitcnt vmcnt(16)
    ds_read_b128 a[240:243], v2 offset:12288
    s_waitcnt lgkmcnt(7)
    v_mfma_f32_32x32x16_bf16 v[112:127], a[192:195], a[0:3], 0
    ds_read_b128 a[244:247], v3 offset:12288
    ds_write_b128 v9, v[88:91] offset:0
    v_mfma_f32_32x32x16_bf16 v[112:127], a[196:199], a[4:7], v[112:127]
    ds_read_b128 a[248:251], v4 offset:12288
    s_add_u32 m0, s53, 0
    s_nop 0
    buffer_load_dwordx4 v10, s[24:27], s60 offen nt lds
    s_add_u32 m0, s53, 1024
    v_mfma_f32_32x32x16_bf16 v[112:127], a[200:203], a[8:11], v[112:127]
    ds_read_b128 a[252:255], v5 offset:12288
    ds_write_b128 v9, v[92:95] offset:1024
    v_mfma_f32_32x32x16_bf16 v[112:127], a[204:207], a[12:15], v[112:127]
    buffer_load_dwordx4 v11, s[24:27], s61 offen nt lds
    s_add_u32 m0, s53, 2048
    s_waitcnt lgkmcnt(6)
    v_mfma_f32_32x32x16_bf16 v[112:127], a[208:211], a[16:19], v[112:127]
    ds_write_b128 v9, v[96:99] offset:2048
    v_mfma_f32_32x32x16_bf16 v[112:127], a[212:215], a[20:23], v[112:127]
    v_mfma_f32_32x32x16_bf16 v[112:127], a[216:219], a[24:27], v[112:127]
    ds_write_b128 v9, v[100:103] offset:3072
    buffer_load_dwordx4 v10, s[24:27], s62 offen nt lds
    s_add_u32 m0, s53, 3072
    v_mfma_f32_32x32x16_bf16 v[112:127], a[220:223], a[28:31], v[112:127]
    v_mfma_f32_32x32x16_bf16 v[112:127], a[224:227], a[32:35], v[112:127]
    ds_write_b128 v9, v[104:107] offset:4096
    v_mfma_f32_32x32x16_bf16 v[112:127], a[228:231], a[36:39], v[112:127]
    buffer_load_dwordx4 v11, s[24:27], s63 offen nt lds
    s_add_u32 m0, s53, 3968
    v_mfma_f32_32x32x16_bf16 v[112:127], a[232:235], a[40:43], v[112:127]
    ds_write_b128 v9, v[108:111] offset:5120
    v_mfma_f32_32x32x16_bf16 v[112:127], a[236:239], a[44:47], v[112:127]
    s_waitcnt lgkmcnt(3)
    v_mfma_f32_32x32x16_bf16 v[112:127], a[240:243], a[48:51], v[112:127]
    buffer_load_dwordx4 v10, s[24:27], s60 offen offset:128 nt lds
    s_add_u32 m0, s53, 4992
    v_mfma_f32_32x32x16_bf16 v[112:127], a[244:247], a[52:55], v[112:127]
    v_mfma_f32_32x32x16_bf16 v[112:127], a[248:251], a[56:59], v[112:127]
    v_mfma_f32_32x32x16_bf16 v[112:127], a[252:255], a[60:63], v[112:127]
    buffer_load_dwordx4 v11, s[24:27], s61 offen offset:128 nt lds
    s_add_u32 m0, s53, 6016
    v_mfma_f32_32x32x16_bf16 v[128:143], a[192:195], a[64:67], 0
    v_mfma_f32_32x32x16_bf16 v[128:143], a[196:199], a[68:71], v[128:143]
    v_mfma_f32_32x32x16_bf16 v[128:143], a[200:203], a[72:75], v[128:143]
    buffer_load_dwordx4 v10, s[24:27], s62 offen offset:128 nt lds
    s_add_u32 m0, s53, 7040
    v_mfma_f32_32x32x16_bf16 v[128:143], a[204:207], a[76:79], v[128:143]
    s_nop 3
    v_fma_f32 v112, v112, s50, v13
    v_fma_f32 v113, v113, s50, v13
    v_mfma_f32_32x32x16_bf16 v[128:143], a[208:211], a[80:83], v[128:143]
    v_exp_f32 v22, v112
    v_fma_f32 v114, v114, s50, v13
    v_exp_f32 v23, v113
    v_fma_f32 v115, v115, s50, v13
    v_mfma_f32_32x32x16_bf16 v[128:143], a[212:215], a[84:87], v[128:143]
    buffer_load_dwordx4 v11, s[24:27], s63 offen offset:128 nt lds
    v_exp_f32 v24, v114
    s_add_u32 m0, s53, 7936
    v_fma_f32 v116, v116, s50, v13
    v_exp_f32 v25, v115
    v_mfma_f32_32x32x16_bf16 v[128:143], a[216:219], a[88:91], v[128:143]
    v_fma_f32 v117, v117, s50, v13
    v_add_f32 v19, v22, v23
    v_cvt_pk_bf16_f32 v88, v22, v23
    v_mfma_f32_32x32x16_bf16 v[128:143], a[220:223], a[92:95], v[128:143]
    v_exp_f32 v26, v116
    v_fma_f32 v118, v118, s50, v13
    v_exp_f32 v27, v117
    v_mfma_f32_32x32x16_bf16 v[128:143], a[224:227], a[96:99], v[128:143]
    buffer_load_dwordx4 v10, s[24:27], s60 offen offset:256 nt lds
    s_add_u32 m0, s53, 8960
    v_fma_f32 v119, v119, s50, v13
    v_add_f32 v19, v19, v24
    v_cvt_pk_bf16_f32 v89, v24, v25
    v_mfma_f32_32x32x16_bf16 v[128:143], a[228:231], a[100:103], v[128:143]
    v_add_f32 v19, v19, v25
    v_exp_f32 v22, v118
    v_mfma_f32_32x32x16_bf16 v[128:143], a[232:235], a[104:107], v[128:143]
    v_fma_f32 v120, v120, s50, v13
    v_exp_f32 v23, v119
    v_fma_f32 v121, v121, s50, v13
    v_mfma_f32_32x32x16_bf16 v[128:143], a[236:239], a[108:111], v[128:143]
    buffer_load_dwordx4 v11, s[24:27], s61 offen offset:256 nt lds
    s_add_u32 m0, s53, 9984
    v_add_f32 v19, v19, v26
    v_cvt_pk_bf16_f32 v90, v26, v27
    v_add_f32 v19, v19, v27
    v_mfma_f32_32x32x16_bf16 v[128:143], a[240:243], a[112:115], v[128:143]
    v_exp_f32 v24, v120
    v_fma_f32 v122, v122, s50, v13
    v_exp_f32 v25, v121
    v_mfma_f32_32x32x16_bf16 v[128:143], a[244:247], a[116:119], v[128:143]
    s_waitcnt lgkmcnt(0)
    s_barrier
    v_fma_f32 v123, v123, s50, v13
    v_add_f32 v19, v19, v22
    v_mfma_f32_32x32x16_bf16 v[128:143], a[248:251], a[120:123], v[128:143]
    buffer_load_dwordx4 v10, s[24:27], s62 offen offset:256 nt lds
    s_add_u32 m0, s53, 11008
    v_cvt_pk_bf16_f32 v91, v22, v23
    v_add_f32 v19, v19, v23
    v_exp_f32 v26, v122
    v_mfma_f32_32x32x16_bf16 v[128:143], a[252:255], a[124:127], v[128:143]
    v_fma_f32 v124, v124, s50, v13
    v_exp_f32 v27, v123
    v_mfma_f32_32x32x16_bf16 v[144:159], a[192:195], a[128:131], 0
    buffer_load_dwordx4 v11, s[24:27], s63 offen offset:256 nt lds
    v_fma_f32 v125, v125, s50, v13
    v_add_f32 v19, v19, v24
    v_cvt_pk_bf16_f32 v92, v24, v25
    v_add_f32 v19, v19, v25
    s_add_u32 m0, s53, 11904
    v_mfma_f32_32x32x16_bf16 v[144:159], a[196:199], a[132:135], v[144:159]
    s_waitcnt vmcnt(26)
    ds_read_b64_tr_b16 v[28:29], v6 offset:0
    v_exp_f32 v22, v124
    ds_read_b64_tr_b16 v[30:31], v6 offset:1024
    v_mfma_f32_32x32x16_bf16 v[144:159], a[200:203], a[136:139], v[144:159]
    ds_read_b128 v[36:39], v8 offset:0
    v_fma_f32 v126, v126, s50, v13
    v_exp_f32 v23, v125
    v_fma_f32 v127, v127, s50, v13
    v_add_f32 v19, v19, v26
    v_mfma_f32_32x32x16_bf16 v[144:159], a[204:207], a[140:143], v[144:159]
    ds_read_b128 v[40:43], v8 offset:2048
    v_cvt_pk_bf16_f32 v93, v26, v27
    v_add_f32 v19, v19, v27
    v_exp_f32 v24, v126
    buffer_load_dwordx4 v10, s[24:27], s60 offen offset:384 nt lds
    v_mfma_f32_32x32x16_bf16 v[144:159], a[208:211], a[144:147], v[144:159]
    ds_read_b128 v[44:47], v8 offset:4096
    s_add_u32 m0, s53, 12928
    v_exp_f32 v25, v127
    ds_read_b64_tr_b16 v[32:33], v7 offset:0
    v_mfma_f32_32x32x16_bf16 v[144:159], a[212:215], a[148:151], v[144:159]
    ds_read_b64_tr_b16 v[34:35], v7 offset:1024
    v_add_f32 v19, v19, v22
    v_cvt_pk_bf16_f32 v94, v22, v23
    s_waitcnt vmcnt(25)
    ds_read_b64_tr_b16 v[48:49], v6 offset:2048
    v_mfma_f32_32x32x16_bf16 v[144:159], a[216:219], a[152:155], v[144:159]
    ds_read_b64_tr_b16 v[50:51], v6 offset:3072
    v_add_f32 v19, v19, v23
    ds_read_b128 v[56:59], v8 offset:1024
    v_add_f32 v19, v19, v24
    v_cvt_pk_bf16_f32 v95, v24, v25
    v_mfma_f32_32x32x16_bf16 v[144:159], a[220:223], a[156:159], v[144:159]
    ds_read_b128 v[60:63], v8 offset:3072
    v_add_f32 v19, v19, v25
    v_fma_f32 v128, v128, s50, v14
    buffer_load_dwordx4 v11, s[24:27], s61 offen offset:384 nt lds
    s_add_u32 m0, s53, 13952
    v_fma_f32 v129, v129, s50, v14
    v_mfma_f32_32x32x16_bf16 v[144:159], a[224:227], a[160:163], v[144:159]
    ds_read_b128 v[64:67], v8 offset:5120
    v_exp_f32 v22, v128
    ds_read_b64_tr_b16 v[52:53], v7 offset:2048
    v_fma_f32 v130, v130, s50, v14
    v_mfma_f32_32x32x16_bf16 v[144:159], a[228:231], a[164:167], v[144:159]
    ds_read_b64_tr_b16 v[54:55], v7 offset:3072
    v_exp_f32 v23, v129
    s_waitcnt vmcnt(24)
    ds_read_b64_tr_b16 v[68:69], v6 offset:4096
    v_mfma_f32_32x32x16_bf16 v[144:159], a[232:235], a[168:171], v[144:159]
    ds_read_b64_tr_b16 v[70:71], v6 offset:5120
    ds_read_b128 v[76:79], v8 offset:6144
    v_fma_f32 v131, v131, s50, v14
    v_exp_f32 v24, v130
    v_mfma_f32_32x32x16_bf16 v[144:159], a[236:239], a[172:175], v[144:159]
    ds_read_b128 v[80:83], v8 offset:8192
    v_fma_f32 v132, v132, s50, v14
    v_exp_f32 v25, v131
    buffer_load_dwordx4 v10, s[24:27], s62 offen offset:384 nt lds
    s_add_u32 m0, s53, 14976
    v_mfma_f32_32x32x16_bf16 v[144:159], a[240:243], a[176:179], v[144:159]
    ds_read_b128 v[84:87], v8 offset:10240
    v_fma_f32 v133, v133, s50, v14
    v_add_f32 v20, v22, v23
    ds_read_b64_tr_b16 v[72:73], v7 offset:4096
    v_cvt_pk_bf16_f32 v96, v22, v23
    v_mfma_f32_32x32x16_bf16 v[144:159], a[244:247], a[180:183], v[144:159]
    ds_read_b64_tr_b16 v[74:75], v7 offset:5120
    v_exp_f32 v26, v132
    v_fma_f32 v134, v134, s50, v14
    v_exp_f32 v27, v133
    v_mfma_f32_32x32x16_bf16 v[144:159], a[248:251], a[184:187], v[144:159]
    buffer_load_dwordx4 v11, s[24:27], s63 offen offset:384 nt lds
    v_fma_f32 v135, v135, s50, v14
    v_add_f32 v20, v20, v24
    v_cvt_pk_bf16_f32 v97, v24, v25
    v_add_f32 v20, v20, v25
    v_exp_f32 v22, v134
    v_mfma_f32_32x32x16_bf16 v[144:159], a[252:255], a[188:191], v[144:159]
    s_add_u32 s60, s60, 65536
    s_add_u32 s61, s61, 65536
    s_add_u32 s62, s62, 65536
    s_add_u32 s63, s63, 65536
    s_add_u32 m0, s54, 0
    v_fma_f32 v136, v136, s50, v14
    s_waitcnt lgkmcnt(4)
    v_mfma_f32_32x32x16_bf16 v[160:175], v[28:31], v[36:39], v[160:175]
    v_exp_f32 v23, v135
    v_fma_f32 v137, v137, s50, v14
    v_add_f32 v20, v20, v26
    v_cvt_pk_bf16_f32 v98, v26, v27
    v_add_f32 v20, v20, v27
    v_mfma_f32_32x32x16_bf16 v[176:191], v[28:31], v[40:43], v[176:191]
    s_add_u32 s56, s56, 4096
    v_exp_f32 v24, v136
    v_fma_f32 v138, v138, s50, v14
    v_exp_f32 v25, v137
    buffer_load_dwordx4 v12, s[28:31], s56 offen nt lds
    v_mfma_f32_32x32x16_bf16 v[192:207], v[28:31], v[44:47], v[192:207]
    s_add_u32 m0, s54, 1024
    v_fma_f32 v139, v139, s50, v14
    v_add_f32 v20, v20, v22
    v_cvt_pk_bf16_f32 v99, v22, v23
    v_add_f32 v20, v20, v23
    v_exp_f32 v26, v138
    v_mfma_f32_32x32x16_bf16 v[208:223], v[32:35], v[36:39], v[208:223]
    v_fma_f32 v140, v140, s50, v14
    v_exp_f32 v27, v139
    v_mfma_f32_32x32x16_bf16 v[224:239], v[32:35], v[40:43], v[224:239]
    s_add_u32 s56, s56, 4096
    buffer_load_dwordx4 v12, s[28:31], s56 offen nt lds
    s_add_u32 m0, s54, 2048
    s_add_u32 s56, s56, 4096
    buffer_load_dwordx4 v12, s[28:31], s56 offen nt lds
    s_add_u32 m0, s54, 3072
    s_add_u32 s56, s56, 4096
    v_mfma_f32_32x32x16_bf16 v[240:255], v[32:35], v[44:47], v[240:255]
    buffer_load_dwordx4 v12, s[28:31], s56 offen nt lds
    s_add_u32 m0, s54, 4096
    s_add_u32 s56, s56, 4096
    s_waitcnt lgkmcnt(0)
    buffer_load_dwordx4 v12, s[28:31], s56 offen nt lds
    s_add_u32 m0, s54, 5120
    s_add_u32 s56, s56, 4096
    v_mfma_f32_32x32x16_bf16 v[160:175], v[48:51], v[56:59], v[160:175]
    buffer_load_dwordx4 v12, s[28:31], s56 offen nt lds
    s_add_u32 m0, s54, 6144
    v_fma_f32 v141, v141, s50, v14
    v_add_f32 v20, v20, v24
    v_cvt_pk_bf16_f32 v100, v24, v25
    v_add_f32 v20, v20, v25
    v_mfma_f32_32x32x16_bf16 v[176:191], v[48:51], v[60:63], v[176:191]
    s_waitcnt vmcnt(30)
    ds_read_b64_tr_b16 v[28:29], v6 offset:6144
    v_exp_f32 v22, v140
    ds_read_b64_tr_b16 v[30:31], v6 offset:7168
    v_mfma_f32_32x32x16_bf16 v[192:207], v[48:51], v[64:67], v[192:207]
    ds_read_b128 v[36:39], v8 offset:7168
    v_fma_f32 v142, v142, s50, v14
    v_exp_f32 v23, v141
    v_fma_f32 v143, v143, s50, v14
    v_add_f32 v20, v20, v26
    v_mfma_f32_32x32x16_bf16 v[208:223], v[52:55], v[56:59], v[208:223]
    ds_read_b128 v[40:43], v8 offset:9216
    v_cvt_pk_bf16_f32 v101, v26, v27
    v_add_f32 v20, v20, v27
    v_exp_f32 v24, v142
    v_mfma_f32_32x32x16_bf16 v[224:239], v[52:55], v[60:63], v[224:239]
    ds_read_b128 v[44:47], v8 offset:11264
    v_exp_f32 v25, v143
    ds_read_b64_tr_b16 v[32:33], v7 offset:6144
    v_add_f32 v20, v20, v22
    v_mfma_f32_32x32x16_bf16 v[240:255], v[52:55], v[64:67], v[240:255]
    ds_read_b64_tr_b16 v[34:35], v7 offset:7168
    v_cvt_pk_bf16_f32 v102, v22, v23
    v_add_f32 v20, v20, v23
    v_add_f32 v20, v20, v24
    v_cvt_pk_bf16_f32 v103, v24, v25
    v_mfma_f32_32x32x16_bf16 v[160:175], v[68:71], v[76:79], v[160:175]
    s_waitcnt vmcnt(28)
    ds_read_b64_tr_b16 v[48:49], v6 offset:8192
    v_add_f32 v20, v20, v25
    v_fma_f32 v144, v144, s50, v15
    v_fma_f32 v145, v145, s50, v15
    v_mfma_f32_32x32x16_bf16 v[176:191], v[68:71], v[80:83], v[176:191]
    ds_read_b64_tr_b16 v[50:51], v6 offset:9216
    v_exp_f32 v22, v144
    v_fma_f32 v146, v146, s50, v15
    v_exp_f32 v23, v145
    v_mfma_f32_32x32x16_bf16 v[192:207], v[68:71], v[84:87], v[192:207]
    ds_read_b128 v[56:59], v8 offset:12288
    v_fma_f32 v147, v147, s50, v15
    v_exp_f32 v24, v146
    v_fma_f32 v148, v148, s50, v15
    v_mfma_f32_32x32x16_bf16 v[208:223], v[72:75], v[76:79], v[208:223]
    ds_read_b128 v[60:63], v8 offset:14336
    v_exp_f32 v25, v147
    ds_read_b128 v[64:67], v8 offset:16384
    v_mfma_f32_32x32x16_bf16 v[224:239], v[72:75], v[80:83], v[224:239]
    s_add_u32 s56, s56, 4096
    s_waitcnt lgkmcnt(5)
    buffer_load_dwordx4 v12, s[28:31], s56 offen nt lds
    s_add_u32 m0, s54, 7168
    v_fma_f32 v149, v149, s50, v15
    v_add_f32 v21, v22, v23
    ds_read_b64_tr_b16 v[52:53], v7 offset:8192
    v_mfma_f32_32x32x16_bf16 v[240:255], v[72:75], v[84:87], v[240:255]
    ds_read_b64_tr_b16 v[54:55], v7 offset:9216
    v_cvt_pk_bf16_f32 v104, v22, v23
    v_exp_f32 v26, v148
    v_fma_f32 v150, v150, s50, v15
    v_mfma_f32_32x32x16_bf16 v[160:175], v[28:31], v[36:39], v[160:175]
    s_add_u32 s56, s56, 4096
    v_exp_f32 v27, v149
    v_fma_f32 v151, v151, s50, v15
    v_add_f32 v21, v21, v24
    v_cvt_pk_bf16_f32 v105, v24, v25
    v_mfma_f32_32x32x16_bf16 v[176:191], v[28:31], v[40:43], v[176:191]
    s_waitcnt vmcnt(27)
    ds_read_b64_tr_b16 v[68:69], v6 offset:10240
    buffer_load_dwordx4 v12, s[28:31], s56 offen nt lds
    s_add_u32 m0, s54, 8192
    v_add_f32 v21, v21, v25
    v_exp_f32 v22, v150
    v_mfma_f32_32x32x16_bf16 v[192:207], v[28:31], v[44:47], v[192:207]
    ds_read_b64_tr_b16 v[70:71], v6 offset:11264
    v_fma_f32 v152, v152, s50, v15
    v_exp_f32 v23, v151
    v_fma_f32 v153, v153, s50, v15
    v_mfma_f32_32x32x16_bf16 v[208:223], v[32:35], v[36:39], v[208:223]
    ds_read_b128 v[76:79], v8 offset:13312
    ds_read_b128 v[80:83], v8 offset:15360
    v_add_f32 v21, v21, v26
    v_cvt_pk_bf16_f32 v106, v26, v27
    v_add_f32 v21, v21, v27
    v_mfma_f32_32x32x16_bf16 v[224:239], v[32:35], v[40:43], v[224:239]
    ds_read_b128 v[84:87], v8 offset:17408
    s_add_u32 s56, s56, 4096
    s_waitcnt lgkmcnt(5)
    buffer_load_dwordx4 v12, s[28:31], s56 offen nt lds
    s_add_u32 m0, s54, 9216
    v_mfma_f32_32x32x16_bf16 v[240:255], v[32:35], v[44:47], v[240:255]
    ds_read_b64_tr_b16 v[72:73], v7 offset:10240
    v_exp_f32 v24, v152
    v_fma_f32 v154, v154, s50, v15
    s_add_u32 s56, s56, 4096
    v_mfma_f32_32x32x16_bf16 v[160:175], v[48:51], v[56:59], v[160:175]
    ds_read_b64_tr_b16 v[74:75], v7 offset:11264
    v_exp_f32 v25, v153
    v_fma_f32 v155, v155, s50, v15
    v_add_f32 v21, v21, v22
    v_mfma_f32_32x32x16_bf16 v[176:191], v[48:51], v[60:63], v[176:191]
    s_waitcnt vmcnt(27)
    ds_read_b64_tr_b16 v[28:29], v6 offset:12288
    v_cvt_pk_bf16_f32 v107, v22, v23
    v_add_f32 v21, v21, v23
    v_exp_f32 v26, v154
    buffer_load_dwordx4 v12, s[28:31], s56 offen nt lds
    v_mfma_f32_32x32x16_bf16 v[192:207], v[48:51], v[64:67], v[192:207]
    s_add_u32 m0, s54, 10240
    v_fma_f32 v156, v156, s50, v15
    v_exp_f32 v27, v155
    ds_read_b64_tr_b16 v[30:31], v6 offset:13312
    v_fma_f32 v157, v157, s50, v15
    v_mfma_f32_32x32x16_bf16 v[208:223], v[52:55], v[56:59], v[208:223]
    ds_read_b128 v[36:39], v8 offset:18432
    v_add_f32 v21, v21, v24
    v_cvt_pk_bf16_f32 v108, v24, v25
    v_add_f32 v21, v21, v25
    v_mfma_f32_32x32x16_bf16 v[224:239], v[52:55], v[60:63], v[224:239]
    ds_read_b128 v[40:43], v8 offset:20480
    v_exp_f32 v22, v156
    v_fma_f32 v158, v158, s50, v15
    s_add_u32 s56, s56, 4096
    v_mfma_f32_32x32x16_bf16 v[240:255], v[52:55], v[64:67], v[240:255]
    ds_read_b128 v[44:47], v8 offset:22528
    v_exp_f32 v23, v157
    s_waitcnt lgkmcnt(5)
    buffer_load_dwordx4 v12, s[28:31], s56 offen nt lds
    s_add_u32 m0, s54, 11264
    v_mfma_f32_32x32x16_bf16 v[160:175], v[68:71], v[76:79], v[160:175]
    ds_read_b64_tr_b16 v[32:33], v7 offset:12288
    v_fma_f32 v159, v159, s50, v15
    v_add_f32 v21, v21, v26
    v_cvt_pk_bf16_f32 v109, v26, v27
    ds_read_b64_tr_b16 v[34:35], v7 offset:13312
    v_mfma_f32_32x32x16_bf16 v[176:191], v[68:71], v[80:83], v[176:191]
    s_add_u32 s56, s56, 4096
    v_add_f32 v21, v21, v27
    v_exp_f32 v24, v158
    v_exp_f32 v25, v159
    v_mfma_f32_32x32x16_bf16 v[192:207], v[68:71], v[84:87], v[192:207]
    s_waitcnt vmcnt(27)
    ds_read_b64_tr_b16 v[48:49], v6 offset:14336
    v_add_f32 v21, v21, v22
    buffer_load_dwordx4 v12, s[28:31], s56 offen nt lds
    s_add_u32 m0, s54, 12288
    v_cvt_pk_bf16_f32 v110, v22, v23
    v_mfma_f32_32x32x16_bf16 v[208:223], v[72:75], v[76:79], v[208:223]
    ds_read_b64_tr_b16 v[50:51], v6 offset:15360
    v_add_f32 v21, v21, v23
    v_add_f32 v21, v21, v24
    v_cvt_pk_bf16_f32 v111, v24, v25
    v_add_f32 v21, v21, v25
    v_max3_f32 v22, v19, v20, v21
    v_mfma_f32_32x32x16_bf16 v[224:239], v[72:75], v[80:83], v[224:239]
    ds_read_b128 v[56:59], v8 offset:19456
    ds_read_b128 v[60:63], v8 offset:21504
    v_cmp_lt_f32 vcc, 0x43800000, v22
    s_add_u32 s56, s56, 4096
    v_mfma_f32_32x32x16_bf16 v[240:255], v[72:75], v[84:87], v[240:255]
    ds_read_b128 v[64:67], v8 offset:23552
    s_waitcnt lgkmcnt(5)
    buffer_load_dwordx4 v12, s[28:31], s56 offen nt lds
    s_add_u32 m0, s54, 13312
    s_cbranch_vccnz L_flag
L_flag_back:
    s_add_u32 s56, s56, 4096
    v_mfma_f32_32x32x16_bf16 v[160:175], v[28:31], v[36:39], v[160:175]
    ds_read_b64_tr_b16 v[52:53], v7 offset:14336
    ds_read_b64_tr_b16 v[54:55], v7 offset:15360
    s_waitcnt vmcnt(25)
    ds_read_b128 a[192:195], v2 offset:0
    buffer_load_dwordx4 v12, s[28:31], s56 offen nt lds
    v_mfma_f32_32x32x16_bf16 v[176:191], v[28:31], v[40:43], v[176:191]
    s_add_u32 m0, s54, 14336
    ds_read_b128 a[196:199], v3 offset:0
    ds_read_b128 a[200:203], v4 offset:0
    v_mfma_f32_32x32x16_bf16 v[192:207], v[28:31], v[44:47], v[192:207]
    ds_read_b128 a[204:207], v5 offset:0
    v_mfma_f32_32x32x16_bf16 v[208:223], v[32:35], v[36:39], v[208:223]
    v_mfma_f32_32x32x16_bf16 v[224:239], v[32:35], v[40:43], v[224:239]
    s_add_u32 s56, s56, 4096
    s_waitcnt lgkmcnt(4)
    buffer_load_dwordx4 v12, s[28:31], s56 offen nt lds
    s_add_u32 m0, s54, 15360
    s_barrier
    ds_read_b32 v22, v8 offset:24576
    v_mfma_f32_32x32x16_bf16 v[240:255], v[32:35], v[44:47], v[240:255]
    s_waitcnt vmcnt(23)
    ds_read_b128 a[208:211], v2 offset:4096
    ds_read_b128 a[212:215], v3 offset:4096
    s_add_u32 s56, s56, 4096
    buffer_load_dwordx4 v12, s[28:31], s56 offen nt lds
    v_mfma_f32_32x32x16_bf16 v[160:175], v[48:51], v[56:59], v[160:175]
    ds_read_b128 a[216:219], v4 offset:4096
    ds_read_b128 a[220:223], v5 offset:4096
    v_mfma_f32_32x32x16_bf16 v[176:191], v[48:51], v[60:63], v[176:191]
    s_waitcnt vmcnt(20)
    ds_read_b128 a[224:227], v2 offset:8192
    v_mfma_f32_32x32x16_bf16 v[192:207], v[48:51], v[64:67], v[192:207]
    ds_read_b128 a[228:231], v3 offset:8192
    ds_read_b128 a[232:235], v4 offset:8192
    v_mfma_f32_32x32x16_bf16 v[208:223], v[52:55], v[56:59], v[208:223]
    ds_read_b128 a[236:239], v5 offset:8192
    v_mfma_f32_32x32x16_bf16 v[224:239], v[52:55], v[60:63], v[224:239]
    s_waitcnt lgkmcnt(8)
    v_cmp_eq_u32 vcc, s51, v22
    s_add_u32 s51, s51, 1
    v_mfma_f32_32x32x16_bf16 v[240:255], v[52:55], v[64:67], v[240:255]
    s_cbranch_vccnz L_rare
L_rare_back:
    v_add_f32 v16, v16, v19
    v_add_f32 v17, v17, v20
    v_add_f32 v18, v18, v21
    s_cmp_lt_u32 s51, 7
    s_cbranch_scc1 L_loop
    s_waitcnt vmcnt(16)
    ds_read_b128 a[240:243], v2 offset:12288
    v_mfma_f32_32x32x16_bf16 v[112:127], a[192:195], a[0:3], 0
    ds_read_b128 a[244:247], v3 offset:12288
    ds_write_b128 v9, v[88:91] offset:0
    s_add_u32 m0, s53, 0
    v_mfma_f32_32x32x16_bf16 v[112:127], a[196:199], a[4:7], v[112:127]
    s_add_u32 s56, s56, 4096
    buffer_load_dwordx4 v12, s[28:31], s56 offen nt lds
    s_add_u32 m0, s53, 1024
    ds_read_b128 a[248:251], v4 offset:12288
    v_mfma_f32_32x32x16_bf16 v[112:127], a[200:203], a[8:11], v[112:127]
    ds_read_b128 a[252:255], v5 offset:12288
    ds_write_b128 v9, v[92:95] offset:1024
    s_add_u32 s56, s56, 4096
    v_mfma_f32_32x32x16_bf16 v[112:127], a[204:207], a[12:15], v[112:127]
    buffer_load_dwordx4 v12, s[28:31], s56 offen nt lds
    s_add_u32 m0, s53, 2048
    s_waitcnt lgkmcnt(6)
    v_mfma_f32_32x32x16_bf16 v[112:127], a[208:211], a[16:19], v[112:127]
    ds_write_b128 v9, v[96:99] offset:2048
    v_mfma_f32_32x32x16_bf16 v[112:127], a[212:215], a[20:23], v[112:127]
    s_add_u32 s56, s56, 4096
    v_bfe_u32 v11, v1, 4, 1
    v_lshlrev_b32 v11, 2, v11
    buffer_load_dwordx4 v12, s[28:31], s56 offen nt lds
    s_add_u32 m0, s53, 3072
    v_and_b32 v2, 7, v1
    v_mfma_f32_32x32x16_bf16 v[112:127], a[216:219], a[24:27], v[112:127]
    ds_write_b128 v9, v[100:103] offset:3072
    v_xor_b32 v11, v11, v2
    v_lshlrev_b32 v11, 4, v11
    v_mfma_f32_32x32x16_bf16 v[112:127], a[220:223], a[28:31], v[112:127]
    v_lshl_add_u32 v11, s48, 8, v11
    v_lshrrev_b32 v2, 3, v1
    v_mfma_f32_32x32x16_bf16 v[112:127], a[224:227], a[32:35], v[112:127]
    ds_write_b128 v9, v[104:107] offset:4096
    v_mul_u32_u24 v2, 896, v2
    v_add_u32 v10, v2, v11
    s_add_u32 s56, s56, 4096
    v_mfma_f32_32x32x16_bf16 v[112:127], a[228:231], a[36:39], v[112:127]
    buffer_load_dwordx4 v12, s[28:31], s56 offen nt lds
    s_add_u32 m0, s53, 4096
    s_mov_b32 s57, 0
    s_cmp_eq_u32 s48, 3
    s_cselect_b32 s59, 0x40000000, 128
    v_bfe_u32 v2, v1, 5, 1
    v_mfma_f32_32x32x16_bf16 v[112:127], a[232:235], a[40:43], v[112:127]
    ds_write_b128 v9, v[108:111] offset:5120
    v_lshlrev_b32 v2, 9, v2
    v_bfe_u32 v11, v1, 2, 2
    v_mfma_f32_32x32x16_bf16 v[112:127], a[236:239], a[44:47], v[112:127]
    s_add_u32 s56, s56, 4096
    v_lshl_or_b32 v2, v11, 7, v2
    v_bfe_u32 v11, v1, 3, 1
    buffer_load_dwordx4 v12, s[28:31], s56 offen nt lds
    s_add_u32 m0, s53, 5120
    v_lshl_or_b32 v2, v11, 6, v2
    s_waitcnt lgkmcnt(3)
    v_mfma_f32_32x32x16_bf16 v[112:127], a[240:243], a[48:51], v[112:127]
    v_bfe_u32 v11, v1, 0, 1
    v_lshl_or_b32 v2, v11, 5, v2
    v_mfma_f32_32x32x16_bf16 v[112:127], a[244:247], a[52:55], v[112:127]
    v_bfe_u32 v11, v1, 4, 1
    v_lshl_or_b32 v2, v11, 4, v2
    v_mfma_f32_32x32x16_bf16 v[112:127], a[248:251], a[56:59], v[112:127]
    s_add_u32 s56, s56, 4096
    v_bfe_u32 v11, v1, 1, 1
    v_lshl_or_b32 v2, v11, 3, v2
    buffer_load_dwordx4 v12, s[28:31], s56 offen nt lds
    s_add_u32 m0, s53, 6144
    v_add_u32 v4, s53, v2
    v_mfma_f32_32x32x16_bf16 v[112:127], a[252:255], a[60:63], v[112:127]
    v_add_u32 v2, s54, v2
    v_xor_b32 v3, 64, v2
    v_mfma_f32_32x32x16_bf16 v[128:143], a[192:195], a[64:67], 0
    v_xor_b32 v5, 64, v4
    v_subrev_u32 v11, 65536, v6
    v_mfma_f32_32x32x16_bf16 v[128:143], a[196:199], a[68:71], v[128:143]
    s_add_u32 s56, s56, 4096
    buffer_load_dwordx4 v12, s[28:31], s56 offen nt lds
    s_add_u32 m0, s53, 7168
    v_mfma_f32_32x32x16_bf16 v[128:143], a[200:203], a[72:75], v[128:143]
    s_nop 1
    v_fma_f32 v112, v112, s50, v13
    v_fma_f32 v113, v113, s50, v13
    v_mfma_f32_32x32x16_bf16 v[128:143], a[204:207], a[76:79], v[128:143]
    v_exp_f32 v22, v112
    v_fma_f32 v114, v114, s50, v13
    v_exp_f32 v23, v113
    v_mfma_f32_32x32x16_bf16 v[128:143], a[208:211], a[80:83], v[128:143]
    s_add_u32 s56, s56, 4096
    buffer_load_dwordx4 v12, s[28:31], s56 offen nt lds
    s_add_u32 m0, s53, 8192
    v_fma_f32 v115, v115, s50, v13
    v_exp_f32 v24, v114
    v_mfma_f32_32x32x16_bf16 v[128:143], a[212:215], a[84:87], v[128:143]
    v_fma_f32 v116, v116, s50, v13
    v_exp_f32 v25, v115
    v_mfma_f32_32x32x16_bf16 v[128:143], a[216:219], a[88:91], v[128:143]
    v_fma_f32 v117, v117, s50, v13
    v_add_f32 v19, v22, v23
    v_cvt_pk_bf16_f32 v88, v22, v23
    v_mfma_f32_32x32x16_bf16 v[128:143], a[220:223], a[92:95], v[128:143]
    s_add_u32 s56, s56, 4096
    v_exp_f32 v26, v116
    buffer_load_dwordx4 v12, s[28:31], s56 offen nt lds
    s_add_u32 m0, s53, 9216
    v_fma_f32 v118, v118, s50, v13
    v_mfma_f32_32x32x16_bf16 v[128:143], a[224:227], a[96:99], v[128:143]
    v_exp_f32 v27, v117
    v_fma_f32 v119, v119, s50, v13
    v_add_f32 v19, v19, v24
    v_cvt_pk_bf16_f32 v89, v24, v25
    v_mfma_f32_32x32x16_bf16 v[128:143], a[228:231], a[100:103], v[128:143]
    v_add_f32 v19, v19, v25
    v_exp_f32 v22, v118
    v_mfma_f32_32x32x16_bf16 v[128:143], a[232:235], a[104:107], v[128:143]
    s_add_u32 s56, s56, 4096
    buffer_load_dwordx4 v12, s[28:31], s56 offen nt lds
    s_add_u32 m0, s53, 10240
    v_fma_f32 v120, v120, s50, v13
    v_exp_f32 v23, v119
    v_fma_f32 v121, v121, s50, v13
    v_mfma_f32_32x32x16_bf16 v[128:143], a[236:239], a[108:111], v[128:143]
    v_add_f32 v19, v19, v26
    v_cvt_pk_bf16_f32 v90, v26, v27
    v_add_f32 v19, v19, v27
    v_mfma_f32_32x32x16_bf16 v[128:143], a[240:243], a[112:115], v[128:143]
    v_exp_f32 v24, v120
    v_fma_f32 v122, v122, s50, v13
    v_exp_f32 v25, v121
    v_mfma_f32_32x32x16_bf16 v[128:143], a[244:247], a[116:119], v[128:143]
    s_waitcnt lgkmcnt(0)
    s_barrier
    s_add_u32 s56, s56, 4096
    buffer_load_dwordx4 v12, s[28:31], s56 offen nt lds
    s_add_u32 m0, s53, 11264
    v_fma_f32 v123, v123, s50, v13
    v_add_f32 v19, v19, v22
    v_mfma_f32_32x32x16_bf16 v[128:143], a[248:251], a[120:123], v[128:143]
    v_cvt_pk_bf16_f32 v91, v22, v23
    v_add_f32 v19, v19, v23
    v_exp_f32 v26, v122
    v_mfma_f32_32x32x16_bf16 v[128:143], a[252:255], a[124:127], v[128:143]
    s_add_u32 s56, s56, 4096
    v_fma_f32 v124, v124, s50, v13
    v_exp_f32 v27, v123
    buffer_load_dwordx4 v12, s[28:31], s56 offen nt lds
    s_add_u32 m0, s53, 12288
    v_mfma_f32_32x32x16_bf16 v[144:159], a[192:195], a[128:131], 0
    v_fma_f32 v125, v125, s50, v13
    v_add_f32 v19, v19, v24
    v_cvt_pk_bf16_f32 v92, v24, v25
    v_add_f32 v19, v19, v25
    v_mfma_f32_32x32x16_bf16 v[144:159], a[196:199], a[132:135], v[144:159]
    s_waitcnt vmcnt(26)
    ds_read_b64_tr_b16 v[28:29], v6 offset:0
    v_exp_f32 v22, v124
    ds_read_b64_tr_b16 v[30:31], v6 offset:1024
    v_mfma_f32_32x32x16_bf16 v[144:159], a[200:203], a[136:139], v[144:159]
    ds_read_b128 v[36:39], v8 offset:0
    v_fma_f32 v126, v126, s50, v13
    v_exp_f32 v23, v125
    v_fma_f32 v127, v127, s50, v13
    s_add_u32 s56, s56, 4096
    v_mfma_f32_32x32x16_bf16 v[144:159], a[204:207], a[140:143], v[144:159]
    buffer_load_dwordx4 v12, s[28:31], s56 offen nt lds
    s_add_u32 m0, s53, 13312
    v_add_f32 v19, v19, v26
    ds_read_b128 v[40:43], v8 offset:2048
    v_cvt_pk_bf16_f32 v93, v26, v27
    v_add_f32 v19, v19, v27
    v_mfma_f32_32x32x16_bf16 v[144:159], a[208:211], a[144:147], v[144:159]
    ds_read_b128 v[44:47], v8 offset:4096
    v_exp_f32 v24, v126
    v_exp_f32 v25, v127
    v_add_f32 v19, v19, v22
    v_mfma_f32_32x32x16_bf16 v[144:159], a[212:215], a[148:151], v[144:159]
    ds_read_b64_tr_b16 v[32:33], v7 offset:0
    v_cvt_pk_bf16_f32 v94, v22, v23
    ds_read_b64_tr_b16 v[34:35], v7 offset:1024
    v_add_f32 v19, v19, v23
    v_mfma_f32_32x32x16_bf16 v[144:159], a[216:219], a[152:155], v[144:159]
    s_waitcnt vmcnt(25)
    ds_read_b64_tr_b16 v[48:49], v6 offset:2048
    ds_read_b64_tr_b16 v[50:51], v6 offset:3072
    ds_read_b128 v[56:59], v8 offset:1024
    v_mfma_f32_32x32x16_bf16 v[144:159], a[220:223], a[156:159], v[144:159]
    s_add_u32 s56, s56, 4096
    v_add_f32 v19, v19, v24
    buffer_load_dwordx4 v12, s[28:31], s56 offen nt lds
    s_add_u32 m0, s53, 14336
    v_cvt_pk_bf16_f32 v95, v24, v25
    ds_read_b128 v[60:63], v8 offset:3072
    v_mfma_f32_32x32x16_bf16 v[144:159], a[224:227], a[160:163], v[144:159]
    ds_read_b128 v[64:67], v8 offset:5120
    v_add_f32 v19, v19, v25
    v_fma_f32 v128, v128, s50, v14
    v_fma_f32 v129, v129, s50, v14
    v_exp_f32 v22, v128
    v_mfma_f32_32x32x16_bf16 v[144:159], a[228:231], a[164:167], v[144:159]
    ds_read_b64_tr_b16 v[52:53], v7 offset:2048
    v_fma_f32 v130, v130, s50, v14
    v_exp_f32 v23, v129
    v_fma_f32 v131, v131, s50, v14
    v_mfma_f32_32x32x16_bf16 v[144:159], a[232:235], a[168:171], v[144:159]
    ds_read_b64_tr_b16 v[54:55], v7 offset:3072
    s_waitcnt vmcnt(24)
    ds_read_b64_tr_b16 v[68:69], v6 offset:4096
    ds_read_b64_tr_b16 v[70:71], v6 offset:5120
    v_mfma_f32_32x32x16_bf16 v[144:159], a[236:239], a[172:175], v[144:159]
    ds_read_b128 v[76:79], v8 offset:6144
    s_add_u32 s56, s56, 4096
    buffer_load_dwordx4 v12, s[28:31], s56 offen nt lds
    s_add_u32 m0, s53, 15360
    v_exp_f32 v24, v130
    v_mfma_f32_32x32x16_bf16 v[144:159], a[240:243], a[176:179], v[144:159]
    ds_read_b128 v[80:83], v8 offset:8192
    v_fma_f32 v132, v132, s50, v14
    v_exp_f32 v25, v131
    ds_read_b128 v[84:87], v8 offset:10240
    v_mfma_f32_32x32x16_bf16 v[144:159], a[244:247], a[180:183], v[144:159]
    ds_read_b64_tr_b16 v[72:73], v7 offset:4096
    v_fma_f32 v133, v133, s50, v14
    v_add_f32 v20, v22, v23
    v_cvt_pk_bf16_f32 v96, v22, v23
    v_exp_f32 v26, v132
    v_mfma_f32_32x32x16_bf16 v[144:159], a[248:251], a[184:187], v[144:159]
    ds_read_b64_tr_b16 v[74:75], v7 offset:5120
    s_add_u32 s56, s56, 4096
    buffer_load_dwordx4 v12, s[28:31], s56 offen nt lds
    s_add_u32 m0, s54, 0
    v_fma_f32 v134, v134, s50, v14
    v_mfma_f32_32x32x16_bf16 v[144:159], a[252:255], a[188:191], v[144:159]
    v_exp_f32 v27, v133
    v_fma_f32 v135, v135, s50, v14
    v_add_f32 v20, v20, v24
    v_cvt_pk_bf16_f32 v97, v24, v25
    s_waitcnt lgkmcnt(7)
    v_mfma_f32_32x32x16_bf16 v[160:175], v[28:31], v[36:39], v[160:175]
    v_add_f32 v20, v20, v25
    v_exp_f32 v22, v134
    v_fma_f32 v136, v136, s50, v14
    v_exp_f32 v23, v135
    v_mfma_f32_32x32x16_bf16 v[176:191], v[28:31], v[40:43], v[176:191]
    buffer_load_dwordx4 v10, s[36:39], s57 offen lds
    v_fma_f32 v137, v137, s50, v14
    v_add_f32 v20, v20, v26
    v_cvt_pk_bf16_f32 v98, v26, v27
    v_add_f32 v20, v20, v27
    v_exp_f32 v24, v136
    v_mfma_f32_32x32x16_bf16 v[192:207], v[28:31], v[44:47], v[192:207]
    s_add_u32 s57, s57, 7168
    v_fma_f32 v138, v138, s50, v14
    v_exp_f32 v25, v137
    s_add_u32 m0, s54, 1024
    v_fma_f32 v139, v139, s50, v14
    v_add_f32 v20, v20, v22
    v_mfma_f32_32x32x16_bf16 v[208:223], v[32:35], v[36:39], v[208:223]
    v_cvt_pk_bf16_f32 v99, v22, v23
    v_add_f32 v20, v20, v23
    v_exp_f32 v26, v138
    v_fma_f32 v140, v140, s50, v14
    v_mfma_f32_32x32x16_bf16 v[224:239], v[32:35], v[40:43], v[224:239]
    buffer_load_dwordx4 v10, s[36:39], s57 offen lds
    v_exp_f32 v27, v139
    s_add_u32 s57, s57, 7168
    s_add_u32 m0, s54, 2048
    v_mfma_f32_32x32x16_bf16 v[240:255], v[32:35], v[44:47], v[240:255]
    buffer_load_dwordx4 v10, s[36:39], s57 offen lds
    s_add_u32 s57, s57, 7168
    s_add_u32 m0, s54, 3072
    s_nop 0
    buffer_load_dwordx4 v10, s[36:39], s57 offen lds
    s_add_u32 s57, s57, 7168
    v_mfma_f32_32x32x16_bf16 v[160:175], v[48:51], v[56:59], v[160:175]
    s_add_u32 m0, s54, 4096
    s_waitcnt lgkmcnt(0)
    buffer_load_dwordx4 v10, s[36:39], s57 offen lds
    s_add_u32 s57, s57, 7168
    s_add_u32 m0, s54, 5120
    s_nop 0
    buffer_load_dwordx4 v10, s[36:39], s57 offen lds
    s_add_u32 s57, s57, 7168
    v_mfma_f32_32x32x16_bf16 v[176:191], v[48:51], v[60:63], v[176:191]
    s_add_u32 m0, s54, 6144
    v_fma_f32 v141, v141, s50, v14
    v_add_f32 v20, v20, v24
    v_cvt_pk_bf16_f32 v100, v24, v25
    v_add_f32 v20, v20, v25
    v_mfma_f32_32x32x16_bf16 v[192:207], v[48:51], v[64:67], v[192:207]
    s_waitcnt vmcnt(30)
    ds_read_b64_tr_b16 v[28:29], v6 offset:6144
    v_exp_f32 v22, v140
    ds_read_b64_tr_b16 v[30:31], v6 offset:7168
    v_fma_f32 v142, v142, s50, v14
    v_mfma_f32_32x32x16_bf16 v[208:223], v[52:55], v[56:59], v[208:223]
    ds_read_b128 v[36:39], v8 offset:7168
    v_exp_f32 v23, v141
    v_fma_f32 v143, v143, s50, v14
    v_add_f32 v20, v20, v26
    v_cvt_pk_bf16_f32 v101, v26, v27
    v_mfma_f32_32x32x16_bf16 v[224:239], v[52:55], v[60:63], v[224:239]
    ds_read_b128 v[40:43], v8 offset:9216
    v_add_f32 v20, v20, v27
    v_exp_f32 v24, v142
    ds_read_b128 v[44:47], v8 offset:11264
    v_mfma_f32_32x32x16_bf16 v[240:255], v[52:55], v[64:67], v[240:255]
    ds_read_b64_tr_b16 v[32:33], v7 offset:6144
    v_exp_f32 v25, v143
    v_add_f32 v20, v20, v22
    v_cvt_pk_bf16_f32 v102, v22, v23
    v_mfma_f32_32x32x16_bf16 v[160:175], v[68:71], v[76:79], v[160:175]
    ds_read_b64_tr_b16 v[34:35], v7 offset:7168
    v_add_f32 v20, v20, v23
    v_add_f32 v20, v20, v24
    v_cvt_pk_bf16_f32 v103, v24, v25
    v_add_f32 v20, v20, v25
    v_mfma_f32_32x32x16_bf16 v[176:191], v[68:71], v[80:83], v[176:191]
    s_waitcnt vmcnt(28)
    ds_read_b64_tr_b16 v[48:49], v6 offset:8192
    v_fma_f32 v144, v144, s50, v15
    v_fma_f32 v145, v145, s50, v15
    v_exp_f32 v22, v144
    v_mfma_f32_32x32x16_bf16 v[192:207], v[68:71], v[84:87], v[192:207]
    ds_read_b64_tr_b16 v[50:51], v6 offset:9216
    v_fma_f32 v146, v146, s50, v15
    v_exp_f32 v23, v145
    ds_read_b128 v[56:59], v8 offset:12288
    v_mfma_f32_32x32x16_bf16 v[208:223], v[72:75], v[76:79], v[208:223]
    s_waitcnt vmcnt(20)
    ds_read_b64_tr_b16 a[128:129], v11 offset:0
    v_fma_f32 v147, v147, s50, v15
    v_exp_f32 v24, v146
    v_fma_f32 v148, v148, s50, v15
    v_mfma_f32_32x32x16_bf16 v[224:239], v[72:75], v[80:83], v[224:239]
    ds_read_b64_tr_b16 a[130:131], v11 offset:1024
    ds_read_b128 v[60:63], v8 offset:14336
    v_exp_f32 v25, v147
    v_mfma_f32_32x32x16_bf16 v[240:255], v[72:75], v[84:87], v[240:255]
    ds_read_b128 v[64:67], v8 offset:16384
    s_waitcnt lgkmcnt(7)
    buffer_load_dwordx4 v10, s[36:39], s57 offen lds
    s_add_u32 s57, s57, 7168
    s_add_u32 m0, s54, 7168
    v_fma_f32 v149, v149, s50, v15
    v_mfma_f32_32x32x16_bf16 v[160:175], v[28:31], v[36:39], v[160:175]
    ds_read_b64_tr_b16 v[52:53], v7 offset:8192
    v_add_f32 v21, v22, v23
    v_cvt_pk_bf16_f32 v104, v22, v23
    v_exp_f32 v26, v148
    v_fma_f32 v150, v150, s50, v15
    v_mfma_f32_32x32x16_bf16 v[176:191], v[28:31], v[40:43], v[176:191]
    ds_read_b64_tr_b16 v[54:55], v7 offset:9216
    v_exp_f32 v27, v149
    s_waitcnt vmcnt(19)
    ds_read_b64_tr_b16 a[136:137], v11 offset:2048
    v_mfma_f32_32x32x16_bf16 v[192:207], v[28:31], v[44:47], v[192:207]
    ds_read_b64_tr_b16 a[138:139], v11 offset:3072
    v_fma_f32 v151, v151, s50, v15
    v_add_f32 v21, v21, v24
    v_cvt_pk_bf16_f32 v105, v24, v25
    buffer_load_dwordx4 v10, s[36:39], s57 offen lds
    v_mfma_f32_32x32x16_bf16 v[208:223], v[32:35], v[36:39], v[208:223]
    ds_read_b64_tr_b16 v[68:69], v6 offset:10240
    s_add_u32 s57, s57, 7168
    s_add_u32 m0, s54, 8192
    v_add_f32 v21, v21, v25
    v_exp_f32 v22, v150
    v_mfma_f32_32x32x16_bf16 v[224:239], v[32:35], v[40:43], v[224:239]
    ds_read_b64_tr_b16 v[70:71], v6 offset:11264
    v_fma_f32 v152, v152, s50, v15
    v_exp_f32 v23, v151
    v_fma_f32 v153, v153, s50, v15
    v_mfma_f32_32x32x16_bf16 v[240:255], v[32:35], v[44:47], v[240:255]
    ds_read_b128 v[76:79], v8 offset:13312
    s_waitcnt vmcnt(18)
    ds_read_b64_tr_b16 a[144:145], v11 offset:4096
    ds_read_b64_tr_b16 a[146:147], v11 offset:5120
    s_waitcnt lgkmcnt(8)
    v_mfma_f32_32x32x16_bf16 v[160:175], v[48:51], v[56:59], v[160:175]
    ds_read_b128 v[80:83], v8 offset:15360
    v_add_f32 v21, v21, v26
    v_cvt_pk_bf16_f32 v106, v26, v27
    v_add_f32 v21, v21, v27
    s_waitcnt lgkmcnt(8)
    buffer_load_dwordx4 v10, s[36:39], s57 offen lds
    v_mfma_f32_32x32x16_bf16 v[176:191], v[48:51], v[60:63], v[176:191]
    ds_read_b128 v[84:87], v8 offset:17408
    s_add_u32 s57, s57, 7168
    s_add_u32 m0, s54, 9216
    v_exp_f32 v24, v152
    v_fma_f32 v154, v154, s50, v15
    v_mfma_f32_32x32x16_bf16 v[192:207], v[48:51], v[64:67], v[192:207]
    ds_read_b64_tr_b16 v[72:73], v7 offset:10240
    v_exp_f32 v25, v153
    ds_read_b64_tr_b16 v[74:75], v7 offset:11264
    v_mfma_f32_32x32x16_bf16 v[208:223], v[52:55], v[56:59], v[208:223]
    s_waitcnt vmcnt(17)
    ds_read_b64_tr_b16 a[152:153], v11 offset:6144
    v_fma_f32 v155, v155, s50, v15
    v_add_f32 v21, v21, v22
    ds_read_b64_tr_b16 a[154:155], v11 offset:7168
    v_mfma_f32_32x32x16_bf16 v[224:239], v[52:55], v[60:63], v[224:239]
    ds_read_b64_tr_b16 v[28:29], v6 offset:12288
    v_cvt_pk_bf16_f32 v107, v22, v23
    v_add_f32 v21, v21, v23
    v_exp_f32 v26, v154
    buffer_load_dwordx4 v10, s[36:39], s57 offen lds
    v_mfma_f32_32x32x16_bf16 v[240:255], v[52:55], v[64:67], v[240:255]
    s_add_u32 s57, s57, 7168
    s_add_u32 m0, s54, 10240
    v_fma_f32 v156, v156, s50, v15
    v_exp_f32 v27, v155
    v_fma_f32 v157, v157, s50, v15
    s_waitcnt lgkmcnt(6)
    v_mfma_f32_32x32x16_bf16 v[160:175], v[68:71], v[76:79], v[160:175]
    ds_read_b64_tr_b16 v[30:31], v6 offset:13312
    v_add_f32 v21, v21, v24
    ds_read_b128 v[36:39], v8 offset:18432
    v_mfma_f32_32x32x16_bf16 v[176:191], v[68:71], v[80:83], v[176:191]
    s_waitcnt vmcnt(16)
    ds_read_b64_tr_b16 a[160:161], v11 offset:8192
    v_cvt_pk_bf16_f32 v108, v24, v25
    v_add_f32 v21, v21, v25
    ds_read_b64_tr_b16 a[162:163], v11 offset:9216
    s_waitcnt lgkmcnt(8)
    v_mfma_f32_32x32x16_bf16 v[192:207], v[68:71], v[84:87], v[192:207]
    ds_read_b128 v[40:43], v8 offset:20480
    v_exp_f32 v22, v156
    v_fma_f32 v158, v158, s50, v15
    ds_read_b128 v[44:47], v8 offset:22528
    s_waitcnt lgkmcnt(7)
    v_mfma_f32_32x32x16_bf16 v[208:223], v[72:75], v[76:79], v[208:223]
    buffer_load_dwordx4 v10, s[36:39], s57 offen lds
    v_exp_f32 v23, v157
    s_add_u32 s57, s57, 7168
    s_add_u32 m0, s54, 11264
    ds_read_b64_tr_b16 v[32:33], v7 offset:12288
    v_mfma_f32_32x32x16_bf16 v[224:239], v[72:75], v[80:83], v[224:239]
    ds_read_b64_tr_b16 v[34:35], v7 offset:13312
    v_fma_f32 v159, v159, s50, v15
    v_add_f32 v21, v21, v26
    v_cvt_pk_bf16_f32 v109, v26, v27
    v_add_f32 v21, v21, v27
    v_mfma_f32_32x32x16_bf16 v[240:255], v[72:75], v[84:87], v[240:255]
    s_waitcnt vmcnt(15)
    ds_read_b64_tr_b16 a[168:169], v11 offset:10240
    v_exp_f32 v24, v158
    ds_read_b64_tr_b16 a[170:171], v11 offset:11264
    s_waitcnt lgkmcnt(8)
    v_mfma_f32_32x32x16_bf16 v[160:175], v[28:31], v[36:39], v[160:175]
    ds_read_b64_tr_b16 v[48:49], v6 offset:14336
    v_exp_f32 v25, v159
    v_add_f32 v21, v21, v22
    buffer_load_dwordx4 v10, s[36:39], s57 offen lds
    s_add_u32 s57, s57, 7168
    s_waitcnt lgkmcnt(6)
    v_mfma_f32_32x32x16_bf16 v[176:191], v[28:31], v[40:43], v[176:191]
    ds_read_b64_tr_b16 v[50:51], v6 offset:15360
    ds_read_b128 v[56:59], v8 offset:19456
    s_add_u32 m0, s54, 12288
    s_waitcnt lgkmcnt(7)
    v_mfma_f32_32x32x16_bf16 v[192:207], v[28:31], v[44:47], v[192:207]
    ds_read_b128 v[60:63], v8 offset:21504
    v_cvt_pk_bf16_f32 v110, v22, v23
    v_add_f32 v21, v21, v23
    v_add_f32 v21, v21, v24
    v_cvt_pk_bf16_f32 v111, v24, v25
    s_waitcnt lgkmcnt(6)
    v_mfma_f32_32x32x16_bf16 v[208:223], v[32:35], v[36:39], v[208:223]
    ds_read_b128 v[64:67], v8 offset:23552
    v_add_f32 v21, v21, v25
    v_max3_f32 v22, v19, v20, v21
    s_waitcnt vmcnt(14)
    ds_read_b64_tr_b16 a[176:177], v11 offset:12288
    v_mfma_f32_32x32x16_bf16 v[224:239], v[32:35], v[40:43], v[224:239]
    ds_read_b64_tr_b16 v[52:53], v7 offset:14336
    ds_read_b64_tr_b16 v[54:55], v7 offset:15360
    ds_read_b64_tr_b16 a[178:179], v11 offset:13312
    v_mfma_f32_32x32x16_bf16 v[240:255], v[32:35], v[44:47], v[240:255]
    buffer_load_dwordx4 v10, s[36:39], s57 offen lds
    v_cmp_lt_f32 vcc, 0x43800000, v22
    s_add_u32 s57, s57, 7168
    s_add_u32 m0, s54, 13312
    s_cbranch_vccnz L_flag
L_flag_back6:
    buffer_load_dwordx4 v10, s[36:39], s57 offen lds
    s_waitcnt lgkmcnt(6)
    v_mfma_f32_32x32x16_bf16 v[160:175], v[48:51], v[56:59], v[160:175]
    s_waitcnt vmcnt(14)
    ds_read_b64_tr_b16 a[184:185], v11 offset:14336
    ds_read_b64_tr_b16 a[186:187], v11 offset:15360
    s_add_u32 s57, s57, 7168
    s_add_u32 m0, s54, 14336
    s_waitcnt lgkmcnt(7)
    v_mfma_f32_32x32x16_bf16 v[176:191], v[48:51], v[60:63], v[176:191]
    s_waitcnt lgkmcnt(6)
    s_barrier
    ds_read_b32 v22, v8 offset:24576
    v_mfma_f32_32x32x16_bf16 v[192:207], v[48:51], v[64:67], v[192:207]
    ds_write_b128 v9, v[88:91] offset:0
    s_waitcnt lgkmcnt(5)
    buffer_load_dwordx4 v10, s[36:39], s57 offen lds
    s_add_u32 s57, s57, 7168
    s_add_u32 m0, s54, 15360
    v_mfma_f32_32x32x16_bf16 v[208:223], v[52:55], v[56:59], v[208:223]
    ds_write_b128 v9, v[92:95] offset:1024
    buffer_load_dwordx4 v10, s[36:39], s57 offen lds
    s_add_u32 s57, s57, 7168
    v_mfma_f32_32x32x16_bf16 v[224:239], v[52:55], v[60:63], v[224:239]
    ds_write_b128 v9, v[96:99] offset:2048
    s_waitcnt lgkmcnt(3)
    v_cmp_eq_u32 vcc, s51, v22
    s_add_u32 s51, s51, 1
    v_mfma_f32_32x32x16_bf16 v[240:255], v[52:55], v[64:67], v[240:255]
    ds_write_b128 v9, v[100:103] offset:3072
    ds_write_b128 v9, v[104:107] offset:4096
    ds_write_b128 v9, v[108:111] offset:5120
    s_cbranch_vccnz L_rare
L_rare_back6:
    v_add_f32 v16, v16, v19
    v_add_f32 v17, v17, v20
    v_add_f32 v18, v18, v21
    s_waitcnt lgkmcnt(0)
    s_barrier
    v_subrev_u32 v7, 65536, v7
    ds_read_b128 a[0:3], v8 offset:0
    ds_read_b128 a[4:7], v8 offset:1024
    ds_read_b128 a[8:11], v8 offset:6144
    ds_read_b128 a[12:15], v8 offset:7168
    ds_read_b128 a[16:19], v8 offset:12288
    s_waitcnt lgkmcnt(4)
    v_mfma_f32_32x32x16_bf16 v[160:175], a[128:131], a[0:3], v[160:175]
    ds_read_b128 a[20:23], v8 offset:13312
    ds_read_b64_tr_b16 a[132:133], v7 offset:0
    ds_read_b64_tr_b16 a[134:135], v7 offset:1024
    s_waitcnt lgkmcnt(6)
    v_mfma_f32_32x32x16_bf16 v[160:175], a[136:139], a[4:7], v[160:175]
    ds_read_b128 a[24:27], v8 offset:18432
    ds_read_b64_tr_b16 a[140:141], v7 offset:2048
    ds_read_b64_tr_b16 a[142:143], v7 offset:3072
    s_waitcnt lgkmcnt(8)
    v_mfma_f32_32x32x16_bf16 v[160:175], a[144:147], a[8:11], v[160:175]
    ds_read_b128 a[28:31], v8 offset:19456
    ds_read_b64_tr_b16 a[148:149], v7 offset:4096
    ds_read_b64_tr_b16 a[150:151], v7 offset:5120
    s_waitcnt lgkmcnt(10)
    v_mfma_f32_32x32x16_bf16 v[160:175], a[152:155], a[12:15], v[160:175]
    ds_read_b64_tr_b16 a[156:157], v7 offset:6144
    v_lshlrev_b32 v12, 4, v1
    ds_read_b64_tr_b16 a[158:159], v7 offset:7168
    v_lshl_add_u32 v6, s48, 11, v12
    s_waitcnt lgkmcnt(11)
    v_mfma_f32_32x32x16_bf16 v[160:175], a[160:163], a[16:19], v[160:175]
    ds_read_b64_tr_b16 a[164:165], v7 offset:8192
    v_add_u32 v9, s53, v12
    ds_read_b64_tr_b16 a[166:167], v7 offset:9216
    s_waitcnt lgkmcnt(12)
    v_mfma_f32_32x32x16_bf16 v[160:175], a[168:171], a[20:23], v[160:175]
    ds_read_b128 a[32:35], v8 offset:2048
    v_mov_b32 v24, v16
    s_nop 1
    v_permlane32_swap_b32 v16, v24
    s_waitcnt lgkmcnt(10)
    v_mfma_f32_32x32x16_bf16 v[160:175], a[176:179], a[24:27], v[160:175]
    ds_read_b64_tr_b16 a[172:173], v7 offset:10240
    ds_read_b64_tr_b16 a[174:175], v7 offset:11264
    v_add_f32 v16, v16, v24
    v_mov_b32 v24, v17
    s_waitcnt lgkmcnt(9)
    v_mfma_f32_32x32x16_bf16 v[160:175], a[184:187], a[28:31], v[160:175]
    ds_read_b64_tr_b16 a[180:181], v7 offset:12288
    ds_read_b64_tr_b16 a[182:183], v7 offset:13312
    v_permlane32_swap_b32 v17, v24
    v_mfma_f32_32x32x16_bf16 v[208:223], a[132:135], a[0:3], v[208:223]
    ds_read_b128 a[36:39], v8 offset:3072
    ds_read_b64_tr_b16 a[188:189], v7 offset:14336
    ds_read_b64_tr_b16 a[190:191], v7 offset:15360
    v_add_f32 v17, v17, v24
    v_mfma_f32_32x32x16_bf16 v[208:223], a[140:143], a[4:7], v[208:223]
    ds_read_b128 a[40:43], v8 offset:8192
    v_mov_b32 v24, v18
    s_nop 1
    v_permlane32_swap_b32 v18, v24
    s_waitcnt lgkmcnt(10)
    v_mfma_f32_32x32x16_bf16 v[208:223], a[148:151], a[8:11], v[208:223]
    ds_read_b128 a[44:47], v8 offset:9216
    v_add_f32 v18, v18, v24
    v_and_b32 v13, 31, v1
    ds_read_b128 a[48:51], v8 offset:14336
    v_mfma_f32_32x32x16_bf16 v[208:223], a[156:159], a[12:15], v[208:223]
    ds_read_b128 a[52:55], v8 offset:15360
    v_lshlrev_b32 v13, 4, v13
    v_add_u32 v13, 156672, v13
    v_lshl_add_u32 v14, s48, 2, v13
    s_waitcnt lgkmcnt(10)
    v_mfma_f32_32x32x16_bf16 v[208:223], a[164:167], a[16:19], v[208:223]
    ds_write_b32 v14, v16 offset:0
    s_waitcnt vmcnt(14)
    ds_read_b64_tr_b16 a[192:193], v2 offset:0
    ds_read_b64_tr_b16 a[194:195], v2 offset:1024
    s_waitcnt lgkmcnt(11)
    v_mfma_f32_32x32x16_bf16 v[208:223], a[172:175], a[20:23], v[208:223]
    ds_read_b128 a[56:59], v8 offset:20480
    ds_write_b32 v14, v17 offset:512
    ds_read_b128 a[60:63], v8 offset:21504
    s_waitcnt lgkmcnt(12)
    v_mfma_f32_32x32x16_bf16 v[208:223], a[180:183], a[24:27], v[208:223]
    ds_write_b32 v14, v18 offset:1024
    ds_read_b128 a[64:67], v8 offset:4096
    ds_read_b64_tr_b16 a[196:197], v3 offset:0
    s_waitcnt lgkmcnt(12)
    v_mfma_f32_32x32x16_bf16 v[208:223], a[188:191], a[28:31], v[208:223]
    ds_read_b64_tr_b16 a[198:199], v3 offset:1024
    ds_read_b128 a[68:71], v8 offset:5120
    v_cvt_pk_bf16_f32 v28, v160, v161
    v_cvt_pk_bf16_f32 v29, v162, v163
    v_mfma_f32_32x32x16_bf16 v[176:191], a[128:131], a[32:35], v[176:191]
    ds_read_b128 a[72:75], v8 offset:10240
    v_cvt_pk_bf16_f32 v30, v164, v165
    s_waitcnt vmcnt(12)
    ds_read_b64_tr_b16 a[200:201], v2 offset:2048
    ds_read_b64_tr_b16 a[202:203], v2 offset:3072
    v_mfma_f32_32x32x16_bf16 v[176:191], a[136:139], a[36:39], v[176:191]
    v_cvt_pk_bf16_f32 v31, v166, v167
    ds_write_b128 v9, v[28:31] offset:0
    v_cvt_pk_bf16_f32 v32, v168, v169
    v_mfma_f32_32x32x16_bf16 v[176:191], a[144:147], a[40:43], v[176:191]
    ds_read_b128 a[76:79], v8 offset:11264
    ds_read_b128 a[80:83], v8 offset:16384
    s_add_u32 m0, s54, 0
    s_waitcnt lgkmcnt(7)
    buffer_load_dwordx4 v10, s[36:39], s57 offen lds
    s_add_u32 s57, s57, 7168
    v_mfma_f32_32x32x16_bf16 v[176:191], a[152:155], a[44:47], v[176:191]
    s_add_u32 m0, s54, 1024
    v_cvt_pk_bf16_f32 v33, v170, v171
    ds_read_b64_tr_b16 a[204:205], v3 offset:2048
    v_cvt_pk_bf16_f32 v34, v172, v173
    v_mfma_f32_32x32x16_bf16 v[176:191], a[160:163], a[48:51], v[176:191]
    ds_read_b64_tr_b16 a[206:207], v3 offset:3072
    v_cvt_pk_bf16_f32 v35, v174, v175
    ds_read_b128 a[84:87], v8 offset:17408
    ds_read_b128 a[88:91], v8 offset:22528
    v_mfma_f32_32x32x16_bf16 v[176:191], a[168:171], a[52:55], v[176:191]
    ds_write_b128 v9, v[32:35] offset:1024
    buffer_load_dwordx4 v10, s[36:39], s57 offen lds
    s_add_u32 s57, s57, 7168
    v_mfma_f32_32x32x16_bf16 v[176:191], a[176:179], a[56:59], v[176:191]
    s_add_u32 m0, s54, 2048
    s_waitcnt vmcnt(12)
    ds_read_b64_tr_b16 a[208:209], v2 offset:4096
    ds_read_b64_tr_b16 a[210:211], v2 offset:5120
    v_cvt_pk_bf16_f32 v36, v208, v209
    v_mfma_f32_32x32x16_bf16 v[176:191], a[184:187], a[60:63], v[176:191]
    ds_read_b128 a[92:95], v8 offset:23552
    s_waitcnt lgkmcnt(6)
    buffer_load_dwordx4 v10, s[36:39], s57 offen lds
    s_add_u32 s57, s57, 7168
    s_add_u32 m0, s54, 3072
    s_nop 0
    buffer_load_dwordx4 v10, s[36:39], s57 offen lds
    v_mfma_f32_32x32x16_bf16 v[224:239], a[132:135], a[32:35], v[224:239]
    ds_read_b64_tr_b16 a[212:213], v3 offset:4096
    ds_read_b64_tr_b16 a[214:215], v3 offset:5120
    s_add_u32 s57, s57, 7168
    s_add_u32 m0, s54, 4096
    v_cvt_pk_bf16_f32 v37, v210, v211
    v_mfma_f32_32x32x16_bf16 v[224:239], a[140:143], a[36:39], v[224:239]
    s_waitcnt vmcnt(12)
    ds_read_b64_tr_b16 a[216:217], v2 offset:6144
    ds_read_b64_tr_b16 a[218:219], v2 offset:7168
    v_cvt_pk_bf16_f32 v38, v212, v213
    v_cvt_pk_bf16_f32 v39, v214, v215
    v_mfma_f32_32x32x16_bf16 v[224:239], a[148:151], a[40:43], v[224:239]
    ds_write_b128 v9, v[36:39] offset:2048
    ds_read_b64_tr_b16 a[220:221], v3 offset:6144
    v_mfma_f32_32x32x16_bf16 v[224:239], a[156:159], a[44:47], v[224:239]
    s_waitcnt lgkmcnt(4)
    buffer_load_dwordx4 v10, s[36:39], s57 offen lds
    s_add_u32 s57, s57, 7168
    s_add_u32 m0, s54, 5120
    ds_read_b64_tr_b16 a[222:223], v3 offset:7168
    v_cvt_pk_bf16_f32 v40, v216, v217
    v_mfma_f32_32x32x16_bf16 v[224:239], a[164:167], a[48:51], v[224:239]
    buffer_load_dwordx4 v10, s[36:39], s57 offen lds
    v_cvt_pk_bf16_f32 v41, v218, v219
    v_cvt_pk_bf16_f32 v42, v220, v221
    v_cvt_pk_bf16_f32 v43, v222, v223
    s_add_u32 s57, s57, 7168
    s_add_u32 m0, s54, 6144
    s_mul_i32 s55, s48, 6144
    v_mfma_f32_32x32x16_bf16 v[224:239], a[172:175], a[52:55], v[224:239]
    ds_write_b128 v9, v[40:43] offset:3072
    s_waitcnt vmcnt(12)
    ds_read_b64_tr_b16 a[224:225], v2 offset:8192
    v_mfma_f32_32x32x16_bf16 v[224:239], a[180:183], a[56:59], v[224:239]
    ds_read_b64_tr_b16 a[226:227], v2 offset:9216
    s_waitcnt lgkmcnt(3)
    buffer_load_dwordx4 v10, s[36:39], s57 offen lds
    s_add_u32 s57, s57, 7168
    s_add_u32 m0, s54, 7168
    s_nop 0
    buffer_load_dwordx4 v10, s[36:39], s57 offen lds
    v_mfma_f32_32x32x16_bf16 v[224:239], a[188:191], a[60:63], v[224:239]
    ds_read_b64_tr_b16 a[228:229], v3 offset:8192
    ds_read_b64_tr_b16 a[230:231], v3 offset:9216
    s_add_u32 s57, s57, 7168
    s_add_u32 m0, s54, 8192
    v_cvt_pk_bf16_f32 v28, v176, v177
    v_mfma_f32_32x32x16_bf16 v[192:207], a[128:131], a[64:67], v[192:207]
    s_waitcnt vmcnt(12)
    ds_read_b64_tr_b16 a[232:233], v2 offset:10240
    ds_read_b64_tr_b16 a[234:235], v2 offset:11264
    v_cvt_pk_bf16_f32 v29, v178, v179
    v_cvt_pk_bf16_f32 v30, v180, v181
    v_mfma_f32_32x32x16_bf16 v[192:207], a[136:139], a[68:71], v[192:207]
    ds_read_b64_tr_b16 a[236:237], v3 offset:10240
    v_cvt_pk_bf16_f32 v31, v182, v183
    ds_read_b64_tr_b16 a[238:239], v3 offset:11264
    s_cmp_eq_u32 s48, 3
    s_cselect_b32 s55, 0x40000000, s55
    v_mfma_f32_32x32x16_bf16 v[192:207], a[144:147], a[72:75], v[192:207]
    s_waitcnt lgkmcnt(4)
    buffer_load_dwordx4 v10, s[36:39], s57 offen lds
    s_add_u32 s57, s57, 7168
    s_add_u32 m0, s54, 9216
    s_nop 0
    buffer_load_dwordx4 v10, s[36:39], s57 offen lds
    s_add_u32 s57, s57, 7168
    s_add_u32 m0, s54, 10240
    v_mfma_f32_32x32x16_bf16 v[192:207], a[152:155], a[76:79], v[192:207]
    ds_write_b128 v9, v[28:31] offset:4096
    v_cvt_pk_bf16_f32 v32, v184, v185
    v_cvt_pk_bf16_f32 v33, v186, v187
    v_mfma_f32_32x32x16_bf16 v[192:207], a[160:163], a[80:83], v[192:207]
    s_waitcnt vmcnt(12)
    ds_read_b64_tr_b16 a[240:241], v2 offset:12288
    v_cvt_pk_bf16_f32 v34, v188, v189
    ds_read_b64_tr_b16 a[242:243], v2 offset:13312
    v_cvt_pk_bf16_f32 v35, v190, v191
    v_mfma_f32_32x32x16_bf16 v[192:207], a[168:171], a[84:87], v[192:207]
    ds_write_b128 v9, v[32:35] offset:5120
    s_waitcnt lgkmcnt(4)
    buffer_load_dwordx4 v10, s[36:39], s57 offen lds
    s_add_u32 s57, s57, 7168
    s_add_u32 m0, s54, 11264
    v_mfma_f32_32x32x16_bf16 v[192:207], a[176:179], a[88:91], v[192:207]
    ds_read_b64_tr_b16 a[244:245], v3 offset:12288
    ds_read_b64_tr_b16 a[246:247], v3 offset:13312
    s_barrier
    buffer_load_dwordx4 v10, s[36:39], s57 offen lds
    v_mfma_f32_32x32x16_bf16 v[192:207], a[184:187], a[92:95], v[192:207]
    ds_read_b128 v[44:47], v13 offset:0
    ds_read_b128 v[48:51], v13 offset:512
    ds_read_b128 v[52:55], v13 offset:1024
    v_mfma_f32_32x32x16_bf16 v[240:255], a[132:135], a[64:67], v[240:255]
    ds_read_b128 a[0:3], v12 offset:0
    s_add_u32 s57, s57, 7168
    s_add_u32 m0, s54, 12288
    s_waitcnt vmcnt(12)
    ds_read_b64_tr_b16 a[248:249], v2 offset:14336
    v_mfma_f32_32x32x16_bf16 v[240:255], a[140:143], a[68:71], v[240:255]
    ds_read_b64_tr_b16 a[250:251], v2 offset:15360
    ds_read_b128 a[4:7], v12 offset:1024
    ds_read_b128 a[8:11], v12 offset:2048
    s_waitcnt lgkmcnt(8)
    buffer_load_dwordx4 v10, s[36:39], s57 offen lds
    v_mfma_f32_32x32x16_bf16 v[240:255], a[148:151], a[72:75], v[240:255]
    s_add_u32 s57, s57, 7168
    s_add_u32 m0, s54, 13312
    ds_read_b64_tr_b16 a[252:253], v3 offset:14336
    ds_read_b64_tr_b16 a[254:255], v3 offset:15360
    v_cvt_pk_bf16_f32 v36, v224, v225
    v_mfma_f32_32x32x16_bf16 v[240:255], a[156:159], a[76:79], v[240:255]
    ds_read_b128 a[12:15], v12 offset:3072
    v_cvt_pk_bf16_f32 v37, v226, v227
    v_cvt_pk_bf16_f32 v38, v228, v229
    v_cvt_pk_bf16_f32 v39, v230, v231
    ds_read_b128 a[16:19], v12 offset:16384
    v_mfma_f32_32x32x16_bf16 v[240:255], a[164:167], a[80:83], v[240:255]
    ds_write_b128 v9, v[36:39] offset:6144
    buffer_load_dwordx4 v10, s[36:39], s57 offen lds
    s_add_u32 s57, s57, 7168
    v_mfma_f32_32x32x16_bf16 v[240:255], a[172:175], a[84:87], v[240:255]
    s_add_u32 m0, s54, 14336
    v_cvt_pk_bf16_f32 v40, v232, v233
    ds_read_b128 a[20:23], v12 offset:17408
    v_cvt_pk_bf16_f32 v41, v234, v235
    v_cvt_pk_bf16_f32 v42, v236, v237
    v_cvt_pk_bf16_f32 v43, v238, v239
    v_mfma_f32_32x32x16_bf16 v[240:255], a[180:183], a[88:91], v[240:255]
    ds_read_b128 a[24:27], v12 offset:18432
    ds_write_b128 v9, v[40:43] offset:7168
    s_waitcnt lgkmcnt(6)
    buffer_load_dwordx4 v10, s[36:39], s57 offen lds
    v_mfma_f32_32x32x16_bf16 v[240:255], a[188:191], a[92:95], v[240:255]
    s_add_u32 s57, s57, 7168
    s_add_u32 m0, s54, 15360
    ds_read_b128 a[28:31], v12 offset:19456
    ds_read_b128 a[32:35], v12 offset:32768
    buffer_load_dwordx4 v10, s[36:39], s57 offen lds
    v_mfma_f32_32x32x16_bf16 v[128:143], a[192:195], a[0:3], 0
    s_add_u32 s57, s57, 7168
    s_add_u32 m0, s54, 0
    v_add_u32 v7, s55, v12
    ds_read_b128 a[36:39], v12 offset:33792
    ds_read_b128 a[40:43], v12 offset:34816
    v_mfma_f32_32x32x16_bf16 v[128:143], a[200:203], a[4:7], v[128:143]
    ds_read_b128 a[44:47], v12 offset:35840
    v_cvt_pk_bf16_f32 v28, v192, v193
    v_cvt_pk_bf16_f32 v29, v194, v195
    ds_read_b128 a[48:51], v12 offset:49152
    v_mfma_f32_32x32x16_bf16 v[128:143], a[208:211], a[8:11], v[128:143]
    v_cvt_pk_bf16_f32 v30, v196, v197
    v_cvt_pk_bf16_f32 v31, v198, v199
    s_waitcnt lgkmcnt(9)
    v_mfma_f32_32x32x16_bf16 v[128:143], a[216:219], a[12:15], v[128:143]
    ds_write_b128 v9, v[28:31] offset:8192
    ds_read_b128 a[52:55], v12 offset:50176
    v_mfma_f32_32x32x16_bf16 v[128:143], a[224:227], a[16:19], v[128:143]
    ds_read_b128 a[56:59], v12 offset:51200
    v_cvt_pk_bf16_f32 v32, v200, v201
    v_cvt_pk_bf16_f32 v33, v202, v203
    v_cvt_pk_bf16_f32 v34, v204, v205
    v_cvt_pk_bf16_f32 v35, v206, v207
    s_waitcnt lgkmcnt(9)
    v_mfma_f32_32x32x16_bf16 v[128:143], a[232:235], a[20:23], v[128:143]
    ds_write_b128 v9, v[32:35] offset:9216
    ds_read_b128 a[60:63], v12 offset:52224
    v_mfma_f32_32x32x16_bf16 v[128:143], a[240:243], a[24:27], v[128:143]
    s_waitcnt vmcnt(14)
    ds_read_b64_tr_b16 v[64:65], v2 offset:0
    ds_read_b64_tr_b16 v[66:67], v2 offset:1024
    s_waitcnt vmcnt(12)
    ds_read_b64_tr_b16 v[68:69], v2 offset:2048
    s_waitcnt lgkmcnt(9)
    v_mfma_f32_32x32x16_bf16 v[128:143], a[248:251], a[28:31], v[128:143]
    ds_read_b64_tr_b16 v[70:71], v2 offset:3072
    v_cvt_pk_bf16_f32 v36, v240, v241
    v_cvt_pk_bf16_f32 v37, v242, v243
    v_cvt_pk_bf16_f32 v38, v244, v245
    v_mfma_f32_32x32x16_bf16 v[144:159], a[196:199], a[0:3], 0
    s_waitcnt vmcnt(10)
    ds_read_b64_tr_b16 v[72:73], v2 offset:4096
    v_cvt_pk_bf16_f32 v39, v246, v247
    ds_read_b64_tr_b16 v[74:75], v2 offset:5120
    v_mfma_f32_32x32x16_bf16 v[144:159], a[204:207], a[4:7], v[144:159]
    ds_write_b128 v9, v[36:39] offset:10240
    s_waitcnt vmcnt(8)
    ds_read_b64_tr_b16 v[76:77], v2 offset:6144
    v_mfma_f32_32x32x16_bf16 v[144:159], a[212:215], a[8:11], v[144:159]
    ds_read_b64_tr_b16 v[78:79], v2 offset:7168
    v_cvt_pk_bf16_f32 v40, v248, v249
    v_cvt_pk_bf16_f32 v41, v250, v251
    v_cvt_pk_bf16_f32 v42, v252, v253
    v_cvt_pk_bf16_f32 v43, v254, v255
    v_mfma_f32_32x32x16_bf16 v[144:159], a[220:223], a[12:15], v[144:159]
    s_waitcnt vmcnt(6)
    ds_read_b64_tr_b16 v[80:81], v2 offset:8192
    ds_read_b64_tr_b16 v[82:83], v2 offset:9216
    s_waitcnt vmcnt(4)
    ds_read_b64_tr_b16 v[84:85], v2 offset:10240
    v_mfma_f32_32x32x16_bf16 v[144:159], a[228:231], a[16:19], v[144:159]
    ds_write_b128 v9, v[40:43] offset:11264
    ds_read_b64_tr_b16 v[86:87], v2 offset:11264
    v_add_f32 v44, v44, v45
    v_mfma_f32_32x32x16_bf16 v[144:159], a[236:239], a[20:23], v[144:159]
    s_waitcnt vmcnt(2)
    ds_read_b64_tr_b16 v[88:89], v2 offset:12288
    ds_read_b64_tr_b16 v[90:91], v2 offset:13312
    s_waitcnt vmcnt(0)
    ds_read_b64_tr_b16 v[92:93], v2 offset:14336
    v_add_f32 v46, v46, v47
    v_mfma_f32_32x32x16_bf16 v[144:159], a[244:247], a[24:27], v[144:159]
    ds_read_b64_tr_b16 v[94:95], v2 offset:15360
    v_add_f32 v44, v44, v46
    ds_read_b64_tr_b16 v[96:97], v3 offset:0
    ds_read_b64_tr_b16 v[98:99], v3 offset:1024
    v_mfma_f32_32x32x16_bf16 v[144:159], a[252:255], a[28:31], v[144:159]
    ds_read_b64_tr_b16 v[100:101], v3 offset:2048
    v_rcp_f32 v16, v44
    v_add_f32 v48, v48, v49
    v_add_f32 v50, v50, v51
    s_waitcnt lgkmcnt(12)
    v_mfma_f32_32x32x16_bf16 v[128:143], v[64:67], a[32:35], v[128:143]
    ds_read_b64_tr_b16 v[102:103], v3 offset:3072
    v_add_f32 v48, v48, v50
    v_rcp_f32 v17, v48
    ds_read_b64_tr_b16 v[104:105], v3 offset:4096
    v_mfma_f32_32x32x16_bf16 v[128:143], v[68:71], a[36:39], v[128:143]
    ds_read_b64_tr_b16 v[106:107], v3 offset:5120
    v_add_f32 v52, v52, v53
    v_add_f32 v54, v54, v55
    ds_read_b64_tr_b16 v[108:109], v3 offset:6144
    v_add_f32 v52, v52, v54
    v_mfma_f32_32x32x16_bf16 v[128:143], v[72:75], a[40:43], v[128:143]
    ds_read_b64_tr_b16 v[110:111], v3 offset:7168
    v_rcp_f32 v18, v52
    ds_read_b64_tr_b16 v[112:113], v3 offset:8192
    v_mfma_f32_32x32x16_bf16 v[128:143], v[76:79], a[44:47], v[128:143]
    ds_read_b64_tr_b16 v[114:115], v3 offset:9216
    s_lshl_b32 s3, s45, 15
    s_add_u32 s3, s3, 23068672
    ds_read_b64_tr_b16 v[116:117], v3 offset:10240
    s_add_u32 s20, s16, s3
    s_addc_u32 s21, s17, 0
    s_waitcnt lgkmcnt(10)
    v_mfma_f32_32x32x16_bf16 v[128:143], v[80:83], a[48:51], v[128:143]
    ds_read_b64_tr_b16 v[118:119], v3 offset:11264
    ds_read_b64_tr_b16 v[120:121], v3 offset:12288
    ds_read_b64_tr_b16 v[122:123], v3 offset:13312
    v_mfma_f32_32x32x16_bf16 v[128:143], v[84:87], a[52:55], v[128:143]
    s_waitcnt lgkmcnt(11)
    buffer_load_dwordx4 v10, s[36:39], s59 offen lds
    s_add_u32 s59, s59, 7168
    s_add_u32 m0, s54, 1024
    s_mov_b32 s22, 32768
    s_barrier
    ds_read_b128 a[64:67], v12 offset:4096
    v_mfma_f32_32x32x16_bf16 v[128:143], v[88:91], a[56:59], v[128:143]
    ds_read_b128 a[68:71], v12 offset:5120
    s_mov_b32 s23, 0x20000
    ds_read_b64_tr_b16 v[124:125], v3 offset:14336
    s_mul_i32 s3, s45, 1378304
    v_mfma_f32_32x32x16_bf16 v[128:143], v[92:95], a[60:63], v[128:143]
    ds_read_b64_tr_b16 v[126:127], v3 offset:15360
    ds_read_b128 a[72:75], v12 offset:6144
    ds_read_b128 a[76:79], v12 offset:7168
    buffer_load_dwordx4 v10, s[36:39], s59 offen lds
    v_mfma_f32_32x32x16_bf16 v[144:159], v[96:99], a[32:35], v[144:159]
    s_add_u32 s59, s59, 7168
    s_add_u32 m0, s54, 2048
    s_add_u32 s3, s3, 128
    ds_read_b128 a[80:83], v12 offset:20480
    s_add_u32 s24, s16, s3
    s_addc_u32 s25, s17, 0
    s_mov_b32 s26, 1378304
    s_waitcnt lgkmcnt(10)
    v_mfma_f32_32x32x16_bf16 v[144:159], v[100:103], a[36:39], v[144:159]
    ds_read_b128 a[84:87], v12 offset:21504
    ds_read_b128 a[88:91], v12 offset:22528
    buffer_load_dwordx4 v10, s[36:39], s59 offen lds
    s_add_u32 s59, s59, 7168
    s_add_u32 m0, s54, 3072
    v_mfma_f32_32x32x16_bf16 v[144:159], v[104:107], a[40:43], v[144:159]
    s_mov_b32 s27, 0x20000
    ds_read_b128 a[92:95], v12 offset:23552
    s_mul_i32 s3, s45, 86016
    ds_read_b128 a[96:99], v12 offset:36864
    s_add_u32 s28, s14, s3
    s_addc_u32 s29, s15, 0
    v_mfma_f32_32x32x16_bf16 v[144:159], v[108:111], a[44:47], v[144:159]
    ds_read_b128 a[100:103], v12 offset:37888
    buffer_load_dwordx4 v10, s[36:39], s59 offen lds
    s_add_u32 s59, s59, 7168
    s_add_u32 m0, s54, 4096
    s_mov_b32 s30, 86016
    s_mov_b32 s31, 0x20000
    v_mfma_f32_32x32x16_bf16 v[144:159], v[112:115], a[48:51], v[144:159]
    ds_read_b128 a[104:107], v12 offset:38912
    ds_read_b128 a[108:111], v12 offset:39936
    ds_read_b128 a[112:115], v12 offset:53248
    s_waitcnt lgkmcnt(9)
    v_mfma_f32_32x32x16_bf16 v[144:159], v[116:119], a[52:55], v[144:159]
    buffer_load_dwordx4 v10, s[36:39], s59 offen lds
    v_mov_b32 v14, s64
    s_add_u32 s59, s59, 7168
    s_add_u32 m0, s54, 5120
    ds_read_b128 a[116:119], v12 offset:54272
    v_mfma_f32_32x32x16_bf16 v[144:159], v[120:123], a[56:59], v[144:159]
    s_lshl_b32 s3, s48, 4
    ds_read_b128 a[120:123], v12 offset:55296
    s_add_u32 s3, s3, s46
    ds_read_b128 a[124:127], v12 offset:56320
    s_lshl_b32 s68, s3, 2
    v_mfma_f32_32x32x16_bf16 v[144:159], v[124:127], a[60:63], v[144:159]
    buffer_load_dwordx4 v10, s[36:39], s59 offen lds
    s_add_u32 s59, s59, 7168
    s_add_u32 m0, s54, 6144
    s_nop 0
    buffer_load_dwordx4 v10, s[36:39], s59 offen lds
    s_add_u32 s59, s59, 7168
    s_add_u32 m0, s54, 7168
    s_mov_b32 s52, 0
    v_mfma_f32_32x32x16_bf16 v[224:239], a[192:195], a[64:67], 0
    buffer_load_dwordx4 v10, s[36:39], s59 offen lds
    v_mul_f32 v128, v128, v16
    v_mul_f32 v129, v129, v16
    v_cvt_pk_bf16_f32 v28, v128, v129
    v_mul_f32 v130, v130, v16
    v_mul_f32 v131, v131, v16
    v_cvt_pk_bf16_f32 v29, v130, v131
    v_mfma_f32_32x32x16_bf16 v[224:239], a[200:203], a[68:71], v[224:239]
    s_add_u32 s59, s59, 7168
    s_add_u32 m0, s54, 8192
    v_mul_f32 v132, v132, v16
    v_mul_f32 v133, v133, v16
    s_barrier
    ds_read_b128 a[128:131], v12 offset:8192
    v_mfma_f32_32x32x16_bf16 v[224:239], a[208:211], a[72:75], v[224:239]
    ds_read_b128 a[132:135], v12 offset:9216
    v_cvt_pk_bf16_f32 v30, v132, v133
    v_mul_f32 v134, v134, v16
    v_mul_f32 v135, v135, v16
    v_cvt_pk_bf16_f32 v31, v134, v135
    buffer_load_dwordx4 v10, s[36:39], s59 offen lds
    v_mfma_f32_32x32x16_bf16 v[224:239], a[216:219], a[76:79], v[224:239]
    s_add_u32 s59, s59, 7168
    s_add_u32 m0, s54, 9216
    ds_read_b128 a[136:139], v12 offset:10240
    buffer_store_dwordx4 v[28:31], v6, s[40:43], s52 offen sc1
    v_mul_f32 v136, v136, v16
    v_mul_f32 v137, v137, v16
    s_waitcnt lgkmcnt(3)
    v_mfma_f32_32x32x16_bf16 v[224:239], a[224:227], a[80:83], v[224:239]
    ds_read_b128 a[140:143], v12 offset:11264
    v_cvt_pk_bf16_f32 v32, v136, v137
    ds_read_b128 a[144:147], v12 offset:24576
    v_mul_f32 v138, v138, v16
    v_mul_f32 v139, v139, v16
    v_mfma_f32_32x32x16_bf16 v[224:239], a[232:235], a[84:87], v[224:239]
    ds_read_b128 a[148:151], v12 offset:25600
    buffer_load_dwordx4 v10, s[36:39], s59 offen lds
    s_add_u32 s59, s59, 7168
    s_add_u32 m0, s54, 10240
    v_cvt_pk_bf16_f32 v33, v138, v139
    v_mul_f32 v140, v140, v16
    v_mfma_f32_32x32x16_bf16 v[224:239], a[240:243], a[88:91], v[224:239]
    ds_read_b128 a[152:155], v12 offset:26624
    v_mul_f32 v141, v141, v16
    v_cvt_pk_bf16_f32 v34, v140, v141
    ds_read_b128 a[156:159], v12 offset:27648
    v_mul_f32 v142, v142, v16
    v_mfma_f32_32x32x16_bf16 v[224:239], a[248:251], a[92:95], v[224:239]
    ds_read_b128 a[160:163], v12 offset:40960
    v_mul_f32 v143, v143, v16
    v_cvt_pk_bf16_f32 v35, v142, v143
    buffer_load_dwordx4 v10, s[36:39], s59 offen lds
    s_add_u32 s59, s59, 7168
    s_add_u32 m0, s54, 11264
    v_mfma_f32_32x32x16_bf16 v[224:239], v[64:67], a[96:99], v[224:239]
    buffer_store_dwordx4 v[32:35], v6, s[40:43], s52 offen offset:1024 sc1
    ds_read_b128 a[164:167], v12 offset:41984
    s_mov_b32 s52, 8192
    v_mul_f32 v144, v144, v16
    ds_read_b128 a[168:171], v12 offset:43008
    v_mfma_f32_32x32x16_bf16 v[224:239], v[68:71], a[100:103], v[224:239]
    ds_read_b128 a[172:175], v12 offset:44032
    v_mul_f32 v145, v145, v16
    v_cvt_pk_bf16_f32 v36, v144, v145
    v_mul_f32 v146, v146, v16
    buffer_load_dwordx4 v10, s[36:39], s59 offen lds
    v_mfma_f32_32x32x16_bf16 v[224:239], v[72:75], a[104:107], v[224:239]
    s_add_u32 s59, s59, 7168
    s_add_u32 m0, s54, 12288
    v_mul_f32 v147, v147, v16
    ds_read_b128 a[176:179], v12 offset:57344
    v_cvt_pk_bf16_f32 v37, v146, v147
    v_mul_f32 v148, v148, v16
    v_mfma_f32_32x32x16_bf16 v[224:239], v[76:79], a[108:111], v[224:239]
    ds_read_b128 a[180:183], v12 offset:58368
    v_mul_f32 v149, v149, v16
    v_cvt_pk_bf16_f32 v38, v148, v149
    ds_read_b128 a[184:187], v12 offset:59392
    v_mul_f32 v150, v150, v16
    v_mfma_f32_32x32x16_bf16 v[224:239], v[80:83], a[112:115], v[224:239]
    buffer_load_dwordx4 v10, s[36:39], s59 offen lds
    v_mul_f32 v151, v151, v16
    s_add_u32 s59, s59, 7168
    s_add_u32 m0, s54, 13312
    ds_read_b128 a[188:191], v12 offset:60416
    v_mfma_f32_32x32x16_bf16 v[224:239], v[84:87], a[116:119], v[224:239]
    v_cvt_pk_bf16_f32 v39, v150, v151
    buffer_store_dwordx4 v[36:39], v6, s[40:43], s52 offen sc1
    v_mul_f32 v152, v152, v16
    v_mul_f32 v153, v153, v16
    v_cvt_pk_bf16_f32 v40, v152, v153
    v_mul_f32 v154, v154, v16
    v_mfma_f32_32x32x16_bf16 v[224:239], v[88:91], a[120:123], v[224:239]
    buffer_load_dwordx4 v10, s[36:39], s59 offen lds
    s_add_u32 s59, s59, 7168
    s_add_u32 m0, s54, 14336
    v_mul_f32 v155, v155, v16
    v_cvt_pk_bf16_f32 v41, v154, v155
    v_mul_f32 v156, v156, v16
    v_mul_f32 v157, v157, v16
    v_mfma_f32_32x32x16_bf16 v[224:239], v[92:95], a[124:127], v[224:239]
    buffer_load_dwordx4 v10, s[36:39], s59 offen lds
    v_cvt_pk_bf16_f32 v42, v156, v157
    v_mul_f32 v158, v158, v16
    s_add_u32 s59, s59, 7168
    s_add_u32 m0, s54, 15360
    v_mul_f32 v159, v159, v16
    v_cvt_pk_bf16_f32 v43, v158, v159
    v_mfma_f32_32x32x16_bf16 v[128:143], a[196:199], a[64:67], 0
    buffer_store_dwordx4 v[40:43], v6, s[40:43], s52 offen offset:1024 sc1
    s_mul_i32 s3, s46, 72
    s_mul_i32 s55, s48, 24
    s_waitcnt lgkmcnt(0)
    s_barrier
    s_add_u32 s3, s3, s55
    v_and_b32 v19, 31, v1
    buffer_load_dwordx4 v10, s[36:39], s59 offen lds
    v_mfma_f32_32x32x16_bf16 v[128:143], a[204:207], a[68:71], v[128:143]
    s_add_u32 s59, s59, 7168
    s_add_u32 m0, s53, 0
    v_add_u32 v22, s3, v19
    v_lshrrev_b32 v23, 6, v22
    v_mul_u32_u24 v24, 171, v23
    v_lshrrev_b32 v24, 10, v24
    v_mul_u32_u24 v25, 6, v24
    v_mfma_f32_32x32x16_bf16 v[128:143], a[212:215], a[72:75], v[128:143]
    buffer_load_dwordx4 v10, s[36:39], s59 offen lds
    v_sub_u32 v23, v23, v25
    v_lshlrev_b32 v21, 8, v24
    s_add_u32 s59, s59, 7168
    s_add_u32 m0, s53, 1024
    v_add_u32 v21, 128, v21
    v_and_b32 v25, 1, v23
    v_mfma_f32_32x32x16_bf16 v[128:143], a[220:223], a[76:79], v[128:143]
    buffer_load_dwordx4 v10, s[36:39], s59 offen lds
    v_lshl_add_u32 v21, v25, 4, v21
    v_bfe_u32 v25, v22, 5, 1
    v_lshl_add_u32 v21, v25, 5, v21
    v_lshrrev_b32 v23, 1, v23
    v_and_b32 v25, 31, v22
    s_add_u32 s59, s59, 7168
    v_mfma_f32_32x32x16_bf16 v[128:143], a[228:231], a[80:83], v[128:143]
    s_add_u32 m0, s53, 2048
    v_lshl_add_u32 v23, v23, 5, v25
    v_mul_u32_u24 v23, 896, v23
    v_add_u32 v21, v21, v23
    v_lshlrev_b32 v20, 4, v22
    v_lshrrev_b32 v23, 5, v1
    v_mul_u32_u24 v23, 689152, v23
    v_mfma_f32_32x32x16_bf16 v[128:143], a[236:239], a[84:87], v[128:143]
    buffer_load_dwordx4 v10, s[36:39], s59 offen lds
    v_add_u32 v20, v20, v23
    s_add_u32 s59, s59, 7168
    s_add_u32 m0, s53, 3072
    v_mov_b32 v23, 0x40000000
    s_mov_b32 s52, 16384
    v_mul_f32 v224, v224, v17
    v_mfma_f32_32x32x16_bf16 v[128:143], a[244:247], a[88:91], v[128:143]
    buffer_load_dwordx4 v10, s[36:39], s59 offen lds
    v_mul_f32 v225, v225, v17
    s_add_u32 s59, s59, 7168
    s_add_u32 m0, s53, 4096
    v_cvt_pk_bf16_f32 v28, v224, v225
    v_mul_f32 v226, v226, v17
    v_mul_f32 v227, v227, v17
    v_mfma_f32_32x32x16_bf16 v[128:143], a[252:255], a[92:95], v[128:143]
    buffer_load_dwordx4 v10, s[36:39], s59 offen lds
    v_cvt_pk_bf16_f32 v29, v226, v227
    v_mul_f32 v228, v228, v17
    v_mul_f32 v229, v229, v17
    s_add_u32 s59, s59, 7168
    s_add_u32 m0, s53, 5120
    v_cvt_pk_bf16_f32 v30, v228, v229
    v_mfma_f32_32x32x16_bf16 v[128:143], v[96:99], a[96:99], v[128:143]
    v_mul_f32 v230, v230, v17
    v_mul_f32 v231, v231, v17
    v_cvt_pk_bf16_f32 v31, v230, v231
    buffer_store_dwordx4 v[28:31], v6, s[40:43], s52 offen sc1
    v_mul_f32 v232, v232, v17
    buffer_load_dwordx4 v10, s[36:39], s59 offen lds
    s_add_u32 s59, s59, 7168
    v_mfma_f32_32x32x16_bf16 v[128:143], v[100:103], a[100:103], v[128:143]
    s_add_u32 m0, s53, 6144
    v_mul_f32 v233, v233, v17
    v_cvt_pk_bf16_f32 v32, v232, v233
    v_mul_f32 v234, v234, v17
    v_mul_f32 v235, v235, v17
    v_cvt_pk_bf16_f32 v33, v234, v235
    v_mul_f32 v236, v236, v17
    v_mfma_f32_32x32x16_bf16 v[128:143], v[104:107], a[104:107], v[128:143]
    buffer_load_dwordx4 v10, s[36:39], s59 offen lds
    v_mul_f32 v237, v237, v17
    s_add_u32 s59, s59, 7168
    s_add_u32 m0, s53, 7168
    v_cvt_pk_bf16_f32 v34, v236, v237
    v_mul_f32 v238, v238, v17
    v_mul_f32 v239, v239, v17
    v_mfma_f32_32x32x16_bf16 v[128:143], v[108:111], a[108:111], v[128:143]
    v_cvt_pk_bf16_f32 v35, v238, v239
    buffer_store_dwordx4 v[32:35], v6, s[40:43], s52 offen offset:1024 sc1
    v_cmp_gt_u32 vcc, 24, v19
    buffer_load_dwordx4 v10, s[36:39], s59 offen lds
    s_add_u32 s59, s59, 7168
    v_mfma_f32_32x32x16_bf16 v[128:143], v[112:115], a[112:115], v[128:143]
    s_add_u32 m0, s53, 8192
    v_cndmask_b32 v20, v23, v20, vcc
    v_cmp_gt_u32 vcc, 24, v1
    s_nop 1
    v_cndmask_b32 v21, v23, v21, vcc
    s_mul_i32 s3, s46, 3
    s_add_u32 s3, s3, s48
    s_lshr_b32 s3, s3, 4
    v_mfma_f32_32x32x16_bf16 v[128:143], v[116:119], a[116:119], v[128:143]
    s_lshl_b32 s3, s3, 6
    buffer_load_dwordx4 v10, s[36:39], s59 offen lds
    s_add_u32 s59, s59, 7168
    s_add_u32 m0, s53, 9216
    s_lshl_b32 s55, s46, 11
    s_add_u32 s3, s3, s55
    v_and_b32 v26, 15, v1
    v_mfma_f32_32x32x16_bf16 v[128:143], v[120:123], a[120:123], v[128:143]
    buffer_load_dwordx4 v10, s[36:39], s59 offen lds
    v_lshl_add_u32 v26, v26, 2, s3
    v_and_b32 v24, 1, v1
    v_bfe_u32 v25, v1, 1, 1
    v_lshl_add_u32 v24, v25, 3, v24
    s_add_u32 s59, s59, 7168
    s_add_u32 m0, s53, 10240
    v_mfma_f32_32x32x16_bf16 v[128:143], v[124:127], a[124:127], v[128:143]
    v_lshl_add_u32 v24, s48, 1, v24
    v_lshlrev_b32 v24, 11, v24
    v_cmp_gt_u32 vcc, 4, v1
    s_nop 1
    v_cndmask_b32 v9, v23, v24, vcc
    s_mul_i32 s3, s48, 5
    v_mfma_f32_32x32x16_bf16 v[144:159], a[192:195], a[128:131], 0
    buffer_load_dwordx4 v10, s[36:39], s59 offen lds
    v_add_u32 v24, s3, v1
    v_lshlrev_b32 v24, 11, v24
    s_add_u32 s59, s59, 7168
    s_add_u32 m0, s53, 11264
    v_mfma_f32_32x32x16_bf16 v[144:159], a[200:203], a[132:135], v[144:159]
    v_cmp_gt_u32 vcc, 6, v1
    s_nop 1
    v_cndmask_b32 v11, v23, v24, vcc
    s_mov_b32 s69, 0xffff0000
    v_mfma_f32_32x32x16_bf16 v[144:159], a[208:211], a[136:139], v[144:159]
    buffer_load_dwordx4 v10, s[36:39], s59 offen lds
    s_add_u32 s59, s59, 7168
    s_add_u32 m0, s53, 12288
    s_mov_b32 s52, 24576
    v_mul_f32 v128, v128, v17
    v_mfma_f32_32x32x16_bf16 v[144:159], a[216:219], a[140:143], v[144:159]
    v_mul_f32 v129, v129, v17
    v_cvt_pk_bf16_f32 v36, v128, v129
    v_mul_f32 v130, v130, v17
    v_mul_f32 v131, v131, v17
    v_mfma_f32_32x32x16_bf16 v[144:159], a[224:227], a[144:147], v[144:159]
    buffer_load_dwordx4 v10, s[36:39], s59 offen lds
    s_add_u32 s59, s59, 7168
    s_add_u32 m0, s53, 13312
    v_cvt_pk_bf16_f32 v37, v130, v131
    v_mul_f32 v132, v132, v17
    v_mul_f32 v133, v133, v17
    v_mfma_f32_32x32x16_bf16 v[144:159], a[232:235], a[148:151], v[144:159]
    v_cvt_pk_bf16_f32 v38, v132, v133
    v_mul_f32 v134, v134, v17
    v_mul_f32 v135, v135, v17
    v_mfma_f32_32x32x16_bf16 v[144:159], a[240:243], a[152:155], v[144:159]
    buffer_load_dwordx4 v10, s[36:39], s59 offen lds
    v_cvt_pk_bf16_f32 v39, v134, v135
    s_add_u32 s59, s59, 7168
    s_add_u32 m0, s53, 14336
    buffer_store_dwordx4 v[36:39], v6, s[40:43], s52 offen sc1
    v_mul_f32 v136, v136, v17
    v_mul_f32 v137, v137, v17
    v_mfma_f32_32x32x16_bf16 v[144:159], a[248:251], a[156:159], v[144:159]
    v_cvt_pk_bf16_f32 v40, v136, v137
    v_mul_f32 v138, v138, v17
    v_mul_f32 v139, v139, v17
    v_mfma_f32_32x32x16_bf16 v[144:159], v[64:67], a[160:163], v[144:159]
    buffer_load_dwordx4 v10, s[36:39], s59 offen lds
    s_add_u32 s59, s59, 7168
    s_add_u32 m0, s53, 15360
    v_cvt_pk_bf16_f32 v41, v138, v139
    v_mul_f32 v140, v140, v17
    v_mul_f32 v141, v141, v17
    v_mfma_f32_32x32x16_bf16 v[144:159], v[68:71], a[164:167], v[144:159]
    buffer_load_dwordx4 v10, s[36:39], s59 offen lds
    v_cvt_pk_bf16_f32 v42, v140, v141
    v_mul_f32 v142, v142, v17
    v_mul_f32 v143, v143, v17
    s_add_u32 s59, s59, 7168
    v_cvt_pk_bf16_f32 v43, v142, v143
    v_mfma_f32_32x32x16_bf16 v[144:159], v[72:75], a[168:171], v[144:159]
    buffer_store_dwordx4 v[40:43], v6, s[40:43], s52 offen offset:1024 sc1
    v_mfma_f32_32x32x16_bf16 v[144:159], v[76:79], a[172:175], v[144:159]
    v_mfma_f32_32x32x16_bf16 v[144:159], v[80:83], a[176:179], v[144:159]
    v_mfma_f32_32x32x16_bf16 v[144:159], v[84:87], a[180:183], v[144:159]
    v_mfma_f32_32x32x16_bf16 v[144:159], v[88:91], a[184:187], v[144:159]
    v_mfma_f32_32x32x16_bf16 v[144:159], v[92:95], a[188:191], v[144:159]
    v_mfma_f32_32x32x16_bf16 v[224:239], a[196:199], a[128:131], 0
    v_mfma_f32_32x32x16_bf16 v[224:239], a[204:207], a[132:135], v[224:239]
    s_waitcnt vmcnt(38)
    ds_read_b64_tr_b16 v[160:161], v2 offset:0
    ds_read_b64_tr_b16 v[162:163], v2 offset:1024
    v_mfma_f32_32x32x16_bf16 v[224:239], a[212:215], a[136:139], v[224:239]
    s_waitcnt vmcnt(36)
    ds_read_b64_tr_b16 v[164:165], v2 offset:2048
    ds_read_b64_tr_b16 v[166:167], v2 offset:3072
    v_mfma_f32_32x32x16_bf16 v[224:239], a[220:223], a[140:143], v[224:239]
    s_mov_b32 s52, 32768
    s_nop 0
    v_mul_f32 v144, v144, v18
    v_mul_f32 v145, v145, v18
    v_cvt_pk_bf16_f32 v28, v144, v145
    v_mul_f32 v146, v146, v18
    v_mfma_f32_32x32x16_bf16 v[224:239], a[228:231], a[144:147], v[224:239]
    s_waitcnt vmcnt(34)
    ds_read_b64_tr_b16 v[168:169], v2 offset:4096
    ds_read_b64_tr_b16 v[170:171], v2 offset:5120
    v_mul_f32 v147, v147, v18
    v_cvt_pk_bf16_f32 v29, v146, v147
    v_mfma_f32_32x32x16_bf16 v[224:239], a[236:239], a[148:151], v[224:239]
    s_waitcnt vmcnt(32)
    ds_read_b64_tr_b16 v[172:173], v2 offset:6144
    v_mul_f32 v148, v148, v18
    ds_read_b64_tr_b16 v[174:175], v2 offset:7168
    v_mul_f32 v149, v149, v18
    v_mfma_f32_32x32x16_bf16 v[224:239], a[244:247], a[152:155], v[224:239]
    s_waitcnt vmcnt(29)
    ds_read_b64_tr_b16 v[176:177], v2 offset:8192
    v_cvt_pk_bf16_f32 v30, v148, v149
    v_mul_f32 v150, v150, v18
    v_mul_f32 v151, v151, v18
    v_cvt_pk_bf16_f32 v31, v150, v151
    v_mfma_f32_32x32x16_bf16 v[224:239], a[252:255], a[156:159], v[224:239]
    ds_read_b64_tr_b16 v[178:179], v2 offset:9216
    buffer_store_dwordx4 v[28:31], v6, s[40:43], s52 offen sc1
    v_mul_f32 v152, v152, v18
    v_mul_f32 v153, v153, v18
    v_cvt_pk_bf16_f32 v32, v152, v153
    v_mfma_f32_32x32x16_bf16 v[224:239], v[96:99], a[160:163], v[224:239]
    s_waitcnt vmcnt(27)
    ds_read_b64_tr_b16 v[180:181], v2 offset:10240
    ds_read_b64_tr_b16 v[182:183], v2 offset:11264
    v_mul_f32 v154, v154, v18
    v_mul_f32 v155, v155, v18
    v_mfma_f32_32x32x16_bf16 v[224:239], v[100:103], a[164:167], v[224:239]
    s_waitcnt vmcnt(24)
    ds_read_b64_tr_b16 v[184:185], v2 offset:12288
    v_cvt_pk_bf16_f32 v33, v154, v155
    v_mul_f32 v156, v156, v18
    ds_read_b64_tr_b16 v[186:187], v2 offset:13312
    v_mfma_f32_32x32x16_bf16 v[224:239], v[104:107], a[168:171], v[224:239]
    s_waitcnt vmcnt(21)
    ds_read_b64_tr_b16 v[188:189], v2 offset:14336
    v_mul_f32 v157, v157, v18
    v_cvt_pk_bf16_f32 v34, v156, v157
    v_mul_f32 v158, v158, v18
    v_mul_f32 v159, v159, v18
    v_mfma_f32_32x32x16_bf16 v[224:239], v[108:111], a[172:175], v[224:239]
    ds_read_b64_tr_b16 v[190:191], v2 offset:15360
    v_cvt_pk_bf16_f32 v35, v158, v159
    buffer_store_dwordx4 v[32:35], v6, s[40:43], s52 offen offset:1024 sc1
    v_mfma_f32_32x32x16_bf16 v[224:239], v[112:115], a[176:179], v[224:239]
    v_mfma_f32_32x32x16_bf16 v[224:239], v[116:119], a[180:183], v[224:239]
    v_mfma_f32_32x32x16_bf16 v[224:239], v[120:123], a[184:187], v[224:239]
    v_mfma_f32_32x32x16_bf16 v[224:239], v[124:127], a[188:191], v[224:239]
    s_cmp_eq_u32 s48, 3
    s_cbranch_scc1 L_w3
    s_waitcnt lgkmcnt(2)
    v_mfma_f32_32x32x16_bf16 v[128:143], v[160:163], a[0:3], 0
    v_mfma_f32_32x32x16_bf16 v[128:143], v[164:167], a[4:7], v[128:143]
    v_mfma_f32_32x32x16_bf16 v[128:143], v[168:171], a[8:11], v[128:143]
    s_mov_b32 s52, 40960
    s_nop 4
    v_mul_f32 v224, v224, v18
    v_mfma_f32_32x32x16_bf16 v[128:143], v[172:175], a[12:15], v[128:143]
    v_mul_f32 v225, v225, v18
    v_cvt_pk_bf16_f32 v36, v224, v225
    v_mul_f32 v226, v226, v18
    v_mul_f32 v227, v227, v18
    v_mfma_f32_32x32x16_bf16 v[128:143], v[176:179], a[16:19], v[128:143]
    v_cvt_pk_bf16_f32 v37, v226, v227
    v_mul_f32 v228, v228, v18
    v_mul_f32 v229, v229, v18
    v_cvt_pk_bf16_f32 v38, v228, v229
    v_mfma_f32_32x32x16_bf16 v[128:143], v[180:183], a[20:23], v[128:143]
    v_mul_f32 v230, v230, v18
    v_mul_f32 v231, v231, v18
    v_cvt_pk_bf16_f32 v39, v230, v231
    buffer_store_dwordx4 v[36:39], v6, s[40:43], s52 offen sc1
    v_mfma_f32_32x32x16_bf16 v[128:143], v[184:187], a[24:27], v[128:143]
    v_mul_f32 v232, v232, v18
    v_mul_f32 v233, v233, v18
    v_cvt_pk_bf16_f32 v40, v232, v233
    v_mul_f32 v234, v234, v18
    s_waitcnt lgkmcnt(0)
    v_mfma_f32_32x32x16_bf16 v[128:143], v[188:191], a[28:31], v[128:143]
    s_waitcnt vmcnt(21)
    ds_read_b64_tr_b16 v[192:193], v4 offset:0
    ds_read_b64_tr_b16 v[194:195], v4 offset:1024
    v_mul_f32 v235, v235, v18
    v_cvt_pk_bf16_f32 v41, v234, v235
    v_mfma_f32_32x32x16_bf16 v[144:159], v[160:163], a[64:67], 0
    s_waitcnt vmcnt(19)
    ds_read_b64_tr_b16 v[196:197], v4 offset:2048
    v_mul_f32 v236, v236, v18
    v_mul_f32 v237, v237, v18
    v_cvt_pk_bf16_f32 v42, v236, v237
    v_mul_f32 v238, v238, v18
    v_mfma_f32_32x32x16_bf16 v[144:159], v[164:167], a[68:71], v[144:159]
    ds_read_b64_tr_b16 v[198:199], v4 offset:3072
    v_mul_f32 v239, v239, v18
    v_cvt_pk_bf16_f32 v43, v238, v239
    buffer_store_dwordx4 v[40:43], v6, s[40:43], s52 offen offset:1024 sc1
    buffer_store_dword v14, v9, s[20:23], s68 offen sc1
    v_mfma_f32_32x32x16_bf16 v[144:159], v[168:171], a[72:75], v[144:159]
    s_waitcnt vmcnt(18)
    ds_read_b64_tr_b16 v[200:201], v4 offset:4096
    ds_read_b64_tr_b16 v[202:203], v4 offset:5120
    v_mfma_f32_32x32x16_bf16 v[144:159], v[172:175], a[76:79], v[144:159]
    s_waitcnt vmcnt(15)
    ds_read_b64_tr_b16 v[204:205], v4 offset:6144
    ds_read_b64_tr_b16 v[206:207], v4 offset:7168
    v_mfma_f32_32x32x16_bf16 v[144:159], v[176:179], a[80:83], v[144:159]
    s_waitcnt vmcnt(13)
    ds_read_b64_tr_b16 v[208:209], v4 offset:8192
    ds_read_b64_tr_b16 v[210:211], v4 offset:9216
    v_mfma_f32_32x32x16_bf16 v[144:159], v[180:183], a[84:87], v[144:159]
    s_waitcnt vmcnt(11)
    ds_read_b64_tr_b16 v[212:213], v4 offset:10240
    ds_read_b64_tr_b16 v[214:215], v4 offset:11264
    v_mfma_f32_32x32x16_bf16 v[144:159], v[184:187], a[88:91], v[144:159]
    s_waitcnt vmcnt(9)
    ds_read_b64_tr_b16 v[216:217], v4 offset:12288
    ds_read_b64_tr_b16 v[218:219], v4 offset:13312
    v_mfma_f32_32x32x16_bf16 v[144:159], v[188:191], a[92:95], v[144:159]
    v_mfma_f32_32x32x16_bf16 v[224:239], v[160:163], a[128:131], 0
    s_waitcnt vmcnt(6)
    ds_read_b64_tr_b16 v[220:221], v4 offset:14336
    ds_read_b64_tr_b16 v[222:223], v4 offset:15360
    v_mfma_f32_32x32x16_bf16 v[224:239], v[164:167], a[132:135], v[224:239]
    v_mfma_f32_32x32x16_bf16 v[224:239], v[168:171], a[136:139], v[224:239]
    v_mfma_f32_32x32x16_bf16 v[224:239], v[172:175], a[140:143], v[224:239]
    ds_read_b64_tr_b16 a[192:193], v3 offset:0
    ds_read_b64_tr_b16 a[194:195], v3 offset:1024
    v_mfma_f32_32x32x16_bf16 v[224:239], v[176:179], a[144:147], v[224:239]
    ds_read_b64_tr_b16 a[196:197], v3 offset:2048
    ds_read_b64_tr_b16 a[198:199], v3 offset:3072
    v_mfma_f32_32x32x16_bf16 v[224:239], v[180:183], a[148:151], v[224:239]
    v_mfma_f32_32x32x16_bf16 v[224:239], v[184:187], a[152:155], v[224:239]
    ds_read_b64_tr_b16 a[200:201], v3 offset:4096
    ds_read_b64_tr_b16 a[202:203], v3 offset:5120
    v_mfma_f32_32x32x16_bf16 v[224:239], v[188:191], a[156:159], v[224:239]
    s_waitcnt vmcnt(5)
    buffer_store_dword v14, v9, s[20:23], s68 offen offset:256 sc1
    ds_read_b64_tr_b16 a[204:205], v3 offset:6144
    ds_read_b64_tr_b16 a[206:207], v3 offset:7168
    s_waitcnt lgkmcnt(8)
    v_mfma_f32_32x32x16_bf16 v[128:143], v[192:195], a[32:35], v[128:143]
    v_mfma_f32_32x32x16_bf16 v[128:143], v[196:199], a[36:39], v[128:143]
    ds_read_b64_tr_b16 a[208:209], v3 offset:8192
    ds_read_b64_tr_b16 a[210:211], v3 offset:9216
    v_mfma_f32_32x32x16_bf16 v[128:143], v[200:203], a[40:43], v[128:143]
    ds_read_b64_tr_b16 a[212:213], v3 offset:10240
    ds_read_b64_tr_b16 a[214:215], v3 offset:11264
    v_mfma_f32_32x32x16_bf16 v[128:143], v[204:207], a[44:47], v[128:143]
    v_mfma_f32_32x32x16_bf16 v[128:143], v[208:211], a[48:51], v[128:143]
    ds_read_b64_tr_b16 a[216:217], v3 offset:12288
    ds_read_b64_tr_b16 a[218:219], v3 offset:13312
    v_mfma_f32_32x32x16_bf16 v[128:143], v[212:215], a[52:55], v[128:143]
    ds_read_b64_tr_b16 a[220:221], v3 offset:14336
    ds_read_b64_tr_b16 a[222:223], v3 offset:15360
    v_mfma_f32_32x32x16_bf16 v[128:143], v[216:219], a[56:59], v[128:143]
    v_mfma_f32_32x32x16_bf16 v[128:143], v[220:223], a[60:63], v[128:143]
    ds_read_b64_tr_b16 a[224:225], v5 offset:0
    ds_read_b64_tr_b16 a[226:227], v5 offset:1024
    v_mfma_f32_32x32x16_bf16 v[144:159], v[192:195], a[96:99], v[144:159]
    ds_read_b64_tr_b16 a[228:229], v5 offset:2048
    ds_read_b64_tr_b16 a[230:231], v5 offset:3072
    v_mfma_f32_32x32x16_bf16 v[144:159], v[196:199], a[100:103], v[144:159]
    v_mfma_f32_32x32x16_bf16 v[144:159], v[200:203], a[104:107], v[144:159]
    ds_read_b64_tr_b16 a[232:233], v5 offset:4096
    ds_read_b64_tr_b16 a[234:235], v5 offset:5120
    s_mov_b32 s52, 49152
    v_mfma_f32_32x32x16_bf16 v[144:159], v[204:207], a[108:111], v[144:159]
    ds_read_b64_tr_b16 a[236:237], v5 offset:6144
    v_mul_f32 v128, v128, v16
    v_mul_f32 v129, v129, v16
    v_cvt_pk_bf16_f32 v28, v128, v129
    ds_read_b64_tr_b16 a[238:239], v5 offset:7168
    v_mfma_f32_32x32x16_bf16 v[144:159], v[208:211], a[112:115], v[144:159]
    v_mul_f32 v130, v130, v16
    v_mul_f32 v131, v131, v16
    v_cvt_pk_bf16_f32 v29, v130, v131
    v_mul_f32 v132, v132, v16
    v_mul_f32 v133, v133, v16
    v_cvt_pk_bf16_f32 v30, v132, v133
    v_mfma_f32_32x32x16_bf16 v[144:159], v[212:215], a[116:119], v[144:159]
    ds_read_b64_tr_b16 a[240:241], v5 offset:8192
    ds_read_b64_tr_b16 a[242:243], v5 offset:9216
    v_mul_f32 v134, v134, v16
    v_mul_f32 v135, v135, v16
    v_cvt_pk_bf16_f32 v31, v134, v135
    v_mfma_f32_32x32x16_bf16 v[144:159], v[216:219], a[120:123], v[144:159]
    buffer_store_dwordx4 v[28:31], v7, s[40:43], s52 offen sc1
    v_mul_f32 v136, v136, v16
    v_mul_f32 v137, v137, v16
    ds_read_b64_tr_b16 a[244:245], v5 offset:10240
    ds_read_b64_tr_b16 a[246:247], v5 offset:11264
    v_mfma_f32_32x32x16_bf16 v[144:159], v[220:223], a[124:127], v[144:159]
    v_cvt_pk_bf16_f32 v32, v136, v137
    v_mul_f32 v138, v138, v16
    v_mul_f32 v139, v139, v16
    v_cvt_pk_bf16_f32 v33, v138, v139
    v_mul_f32 v140, v140, v16
    v_mul_f32 v141, v141, v16
    v_mfma_f32_32x32x16_bf16 v[224:239], v[192:195], a[160:163], v[224:239]
    ds_read_b64_tr_b16 a[248:249], v5 offset:12288
    ds_read_b64_tr_b16 a[250:251], v5 offset:13312
    v_cvt_pk_bf16_f32 v34, v140, v141
    v_mul_f32 v142, v142, v16
    v_mul_f32 v143, v143, v16
    v_mfma_f32_32x32x16_bf16 v[224:239], v[196:199], a[164:167], v[224:239]
    v_cvt_pk_bf16_f32 v35, v142, v143
    buffer_store_dwordx4 v[32:35], v7, s[40:43], s52 offen offset:1024 sc1
    ds_read_b64_tr_b16 a[252:253], v5 offset:14336
    ds_read_b64_tr_b16 a[254:255], v5 offset:15360
    v_mfma_f32_32x32x16_bf16 v[224:239], v[200:203], a[168:171], v[224:239]
    s_mov_b32 s52, 51200
    v_mul_f32 v144, v144, v17
    v_mfma_f32_32x32x16_bf16 v[224:239], v[204:207], a[172:175], v[224:239]
    v_mul_f32 v145, v145, v17
    v_cvt_pk_bf16_f32 v36, v144, v145
    v_mul_f32 v146, v146, v17
    v_mul_f32 v147, v147, v17
    v_mfma_f32_32x32x16_bf16 v[224:239], v[208:211], a[176:179], v[224:239]
    v_cvt_pk_bf16_f32 v37, v146, v147
    v_mul_f32 v148, v148, v17
    v_mul_f32 v149, v149, v17
    v_cvt_pk_bf16_f32 v38, v148, v149
    v_mfma_f32_32x32x16_bf16 v[224:239], v[212:215], a[180:183], v[224:239]
    v_mul_f32 v150, v150, v17
    v_mul_f32 v151, v151, v17
    v_cvt_pk_bf16_f32 v39, v150, v151
    buffer_store_dwordx4 v[36:39], v7, s[40:43], s52 offen sc1
    v_mfma_f32_32x32x16_bf16 v[224:239], v[216:219], a[184:187], v[224:239]
    v_mul_f32 v152, v152, v17
    v_mul_f32 v153, v153, v17
    v_cvt_pk_bf16_f32 v40, v152, v153
    v_mul_f32 v154, v154, v17
    v_mfma_f32_32x32x16_bf16 v[224:239], v[220:223], a[188:191], v[224:239]
    v_mul_f32 v155, v155, v17
    v_cvt_pk_bf16_f32 v41, v154, v155
    v_mul_f32 v156, v156, v17
    v_mul_f32 v157, v157, v17
    s_waitcnt lgkmcnt(0)
    v_mfma_f32_32x32x16_bf16 v[128:143], a[192:195], a[0:3], 0
    v_cvt_pk_bf16_f32 v42, v156, v157
    v_mul_f32 v158, v158, v17
    v_mul_f32 v159, v159, v17
    v_cvt_pk_bf16_f32 v43, v158, v159
    v_mfma_f32_32x32x16_bf16 v[128:143], a[196:199], a[4:7], v[128:143]
    buffer_store_dwordx4 v[40:43], v7, s[40:43], s52 offen offset:1024 sc1
    s_waitcnt vmcnt(6)
    buffer_store_dword v14, v9, s[20:23], s68 offen offset:512 sc1
    v_mfma_f32_32x32x16_bf16 v[128:143], a[200:203], a[8:11], v[128:143]
    s_mov_b32 s52, 53248
    v_mul_f32 v224, v224, v18
    v_mfma_f32_32x32x16_bf16 v[128:143], a[204:207], a[12:15], v[128:143]
    v_mul_f32 v225, v225, v18
    v_cvt_pk_bf16_f32 v28, v224, v225
    v_mul_f32 v226, v226, v18
    v_mul_f32 v227, v227, v18
    v_mfma_f32_32x32x16_bf16 v[128:143], a[208:211], a[16:19], v[128:143]
    v_cvt_pk_bf16_f32 v29, v226, v227
    v_mul_f32 v228, v228, v18
    v_mul_f32 v229, v229, v18
    v_cvt_pk_bf16_f32 v30, v228, v229
    v_mfma_f32_32x32x16_bf16 v[128:143], a[212:215], a[20:23], v[128:143]
    v_mul_f32 v230, v230, v18
    v_mul_f32 v231, v231, v18
    v_cvt_pk_bf16_f32 v31, v230, v231
    buffer_store_dwordx4 v[28:31], v7, s[40:43], s52 offen sc1
    v_mfma_f32_32x32x16_bf16 v[128:143], a[216:219], a[24:27], v[128:143]
    v_mul_f32 v232, v232, v18
    v_mul_f32 v233, v233, v18
    v_cvt_pk_bf16_f32 v32, v232, v233
    v_mul_f32 v234, v234, v18
    v_mfma_f32_32x32x16_bf16 v[128:143], a[220:223], a[28:31], v[128:143]
    v_mul_f32 v235, v235, v18
    v_cvt_pk_bf16_f32 v33, v234, v235
    v_mul_f32 v236, v236, v18
    v_mul_f32 v237, v237, v18
    v_mfma_f32_32x32x16_bf16 v[128:143], a[224:227], a[32:35], v[128:143]
    v_cvt_pk_bf16_f32 v34, v236, v237
    v_mul_f32 v238, v238, v18
    v_mul_f32 v239, v239, v18
    v_cvt_pk_bf16_f32 v35, v238, v239
    v_mfma_f32_32x32x16_bf16 v[128:143], a[228:231], a[36:39], v[128:143]
    buffer_store_dwordx4 v[32:35], v7, s[40:43], s52 offen offset:1024 sc1
    v_bfe_u32 v56, v1, 3, 1
    v_bfe_u32 v57, v1, 1, 1
    v_lshl_add_u32 v56, v56, 1, v57
    v_mfma_f32_32x32x16_bf16 v[128:143], a[232:235], a[40:43], v[128:143]
    v_and_b32 v57, 1, v1
    v_lshlrev_b32 v57, 4, v57
    v_mfma_f32_32x32x16_bf16 v[128:143], a[236:239], a[44:47], v[128:143]
    v_mov_b32 v58, 0x3f80
    v_lshlrev_b32 v57, v57, v58
    v_mfma_f32_32x32x16_bf16 v[128:143], a[240:243], a[48:51], v[128:143]
    v_bfe_u32 v58, v1, 4, 1
    v_lshl_add_u32 v56, v58, 2, v56
    v_mfma_f32_32x32x16_bf16 v[128:143], a[244:247], a[52:55], v[128:143]
    v_cmp_eq_u32 vcc, 0, v56
    s_nop 1
    v_cndmask_b32 v60, 0, v57, vcc
    v_mfma_f32_32x32x16_bf16 v[128:143], a[248:251], a[56:59], v[128:143]
    v_cmp_eq_u32 vcc, 1, v56
    s_nop 1
    v_cndmask_b32 v61, 0, v57, vcc
    v_mfma_f32_32x32x16_bf16 v[128:143], a[252:255], a[60:63], v[128:143]
    v_cmp_eq_u32 vcc, 2, v56
    s_nop 1
    v_cndmask_b32 v62, 0, v57, vcc
    v_mfma_f32_32x32x16_bf16 v[144:159], a[192:195], a[64:67], 0
    v_cmp_eq_u32 vcc, 3, v56
    s_nop 1
    v_cndmask_b32 v63, 0, v57, vcc
    v_mfma_f32_32x32x16_bf16 v[144:159], a[196:199], a[68:71], v[144:159]
    v_mfma_f32_32x32x16_bf16 v[144:159], a[200:203], a[72:75], v[144:159]
    s_mov_b32 s52, 67584
    v_mul_f32 v128, v128, v16
    v_mfma_f32_32x32x16_bf16 v[144:159], a[204:207], a[76:79], v[144:159]
    v_mul_f32 v129, v129, v16
    v_cvt_pk_bf16_f32 v36, v128, v129
    v_mul_f32 v130, v130, v16
    v_mul_f32 v131, v131, v16
    v_mfma_f32_32x32x16_bf16 v[144:159], a[208:211], a[80:83], v[144:159]
    v_cvt_pk_bf16_f32 v37, v130, v131
    v_mul_f32 v132, v132, v16
    v_mul_f32 v133, v133, v16
    v_cvt_pk_bf16_f32 v38, v132, v133
    v_mfma_f32_32x32x16_bf16 v[144:159], a[212:215], a[84:87], v[144:159]
    v_mul_f32 v134, v134, v16
    v_mul_f32 v135, v135, v16
    v_cvt_pk_bf16_f32 v39, v134, v135
    buffer_store_dwordx4 v[36:39], v7, s[40:43], s52 offen sc1
    v_mfma_f32_32x32x16_bf16 v[144:159], a[216:219], a[88:91], v[144:159]
    v_mul_f32 v136, v136, v16
    v_mul_f32 v137, v137, v16
    v_cvt_pk_bf16_f32 v40, v136, v137
    v_mul_f32 v138, v138, v16
    v_mfma_f32_32x32x16_bf16 v[144:159], a[220:223], a[92:95], v[144:159]
    v_mul_f32 v139, v139, v16
    v_cvt_pk_bf16_f32 v41, v138, v139
    v_mul_f32 v140, v140, v16
    v_mul_f32 v141, v141, v16
    v_mfma_f32_32x32x16_bf16 v[144:159], a[224:227], a[96:99], v[144:159]
    v_cvt_pk_bf16_f32 v42, v140, v141
    v_mul_f32 v142, v142, v16
    v_mul_f32 v143, v143, v16
    v_cvt_pk_bf16_f32 v43, v142, v143
    v_mfma_f32_32x32x16_bf16 v[144:159], a[228:231], a[100:103], v[144:159]
    buffer_store_dwordx4 v[40:43], v7, s[40:43], s52 offen offset:1024 sc1
    v_mfma_f32_32x32x16_bf16 v[144:159], a[232:235], a[104:107], v[144:159]
    v_mfma_f32_32x32x16_bf16 v[144:159], a[236:239], a[108:111], v[144:159]
    s_waitcnt vmcnt(2)
    buffer_store_dword v14, v11, s[20:23], s68 offen offset:768 sc1
    v_mfma_f32_32x32x16_bf16 v[144:159], a[240:243], a[112:115], v[144:159]
    v_mfma_f32_32x32x16_bf16 v[144:159], a[244:247], a[116:119], v[144:159]
    v_mfma_f32_32x32x16_bf16 v[144:159], a[248:251], a[120:123], v[144:159]
    v_mfma_f32_32x32x16_bf16 v[144:159], a[252:255], a[124:127], v[144:159]
    v_mfma_f32_32x32x16_bf16 v[224:239], a[192:195], a[128:131], 0
    v_mfma_f32_32x32x16_bf16 v[224:239], a[196:199], a[132:135], v[224:239]
    v_mfma_f32_32x32x16_bf16 v[224:239], a[200:203], a[136:139], v[224:239]
    v_mfma_f32_32x32x16_bf16 v[224:239], a[204:207], a[140:143], v[224:239]
    v_mfma_f32_32x32x16_bf16 v[224:239], a[208:211], a[144:147], v[224:239]
    s_mov_b32 s52, 69632
    s_nop 5
    v_mul_f32 v144, v144, v17
    v_mul_f32 v145, v145, v17
    v_cvt_pk_bf16_f32 v28, v144, v145
    v_mul_f32 v146, v146, v17
    v_mul_f32 v147, v147, v17
    v_cvt_pk_bf16_f32 v29, v146, v147
    v_mfma_f32_32x32x16_bf16 v[224:239], a[212:215], a[148:151], v[224:239]
    v_mul_f32 v148, v148, v17
    v_mul_f32 v149, v149, v17
    v_cvt_pk_bf16_f32 v30, v148, v149
    v_mul_f32 v150, v150, v17
    v_mul_f32 v151, v151, v17
    v_cvt_pk_bf16_f32 v31, v150, v151
    buffer_store_dwordx4 v[28:31], v7, s[40:43], s52 offen sc1
    v_mfma_f32_32x32x16_bf16 v[224:239], a[216:219], a[152:155], v[224:239]
    v_mul_f32 v152, v152, v17
    v_mul_f32 v153, v153, v17
    v_cvt_pk_bf16_f32 v32, v152, v153
    v_mul_f32 v154, v154, v17
    v_mfma_f32_32x32x16_bf16 v[224:239], a[220:223], a[156:159], v[224:239]
    v_mul_f32 v155, v155, v17
    v_cvt_pk_bf16_f32 v33, v154, v155
    v_mul_f32 v156, v156, v17
    v_mul_f32 v157, v157, v17
    v_mfma_f32_32x32x16_bf16 v[224:239], a[224:227], a[160:163], v[224:239]
    v_cvt_pk_bf16_f32 v34, v156, v157
    v_mul_f32 v158, v158, v17
    v_mul_f32 v159, v159, v17
    v_cvt_pk_bf16_f32 v35, v158, v159
    v_mfma_f32_32x32x16_bf16 v[224:239], a[228:231], a[164:167], v[224:239]
    buffer_store_dwordx4 v[32:35], v7, s[40:43], s52 offen offset:1024 sc1
    v_mfma_f32_32x32x16_bf16 v[224:239], a[232:235], a[168:171], v[224:239]
    v_mfma_f32_32x32x16_bf16 v[224:239], a[236:239], a[172:175], v[224:239]
    v_mfma_f32_32x32x16_bf16 v[224:239], a[240:243], a[176:179], v[224:239]
    v_mfma_f32_32x32x16_bf16 v[224:239], a[244:247], a[180:183], v[224:239]
    v_mfma_f32_32x32x16_bf16 v[224:239], a[248:251], a[184:187], v[224:239]
    v_mfma_f32_32x32x16_bf16 v[224:239], a[252:255], a[188:191], v[224:239]
    buffer_load_dword v27, v26, s[20:23], 0 offen offset:768 sc1
    s_mov_b32 s52, 71680
    s_nop 9
    v_mul_f32 v224, v224, v18
    v_mul_f32 v225, v225, v18
    v_cvt_pk_bf16_f32 v36, v224, v225
    v_mul_f32 v226, v226, v18
    v_mul_f32 v227, v227, v18
    v_cvt_pk_bf16_f32 v37, v226, v227
    v_mul_f32 v228, v228, v18
    v_mul_f32 v229, v229, v18
    v_cvt_pk_bf16_f32 v38, v228, v229
    v_mul_f32 v230, v230, v18
    v_mul_f32 v231, v231, v18
    v_cvt_pk_bf16_f32 v39, v230, v231
    buffer_store_dwordx4 v[36:39], v7, s[40:43], s52 offen sc1
    v_mul_f32 v232, v232, v18
    v_mul_f32 v233, v233, v18
    v_cvt_pk_bf16_f32 v40, v232, v233
    v_mul_f32 v234, v234, v18
    v_mul_f32 v235, v235, v18
    v_cvt_pk_bf16_f32 v41, v234, v235
    v_mul_f32 v236, v236, v18
    v_mul_f32 v237, v237, v18
    v_cvt_pk_bf16_f32 v42, v236, v237
    v_mul_f32 v238, v238, v18
    v_mul_f32 v239, v239, v18
    v_cvt_pk_bf16_f32 v43, v238, v239
    buffer_store_dwordx4 v[40:43], v7, s[40:43], s52 offen offset:1024 sc1
    s_waitcnt vmcnt(0)
    buffer_store_dword v14, v11, s[20:23], s68 offen offset:1024 sc1
    v_cmp_ne_u32 vcc, s64, v27
    s_nop 0
    s_cbranch_vccz L_pdoneB0
    s_mov_b32 s65, 0
L_pollB0:
    buffer_load_dword v27, v26, s[20:23], 0 offen offset:768 sc1
    s_waitcnt vmcnt(0)
    v_cmp_ne_u32 vcc, s64, v27
    s_add_u32 s65, s65, 1
    s_cbranch_vccz L_pdoneB0
    s_sleep 1
    s_cmp_lt_u32 s65, 20000
    s_cbranch_scc1 L_pollB0
L_pdoneB0:
    s_mov_b32 s3, 49152
    buffer_load_dwordx4 v[64:67], v20, s[24:27], s3 offen sc1
    s_add_u32 s3, s3, 86144
    buffer_load_dwordx4 v[68:71], v20, s[24:27], s3 offen sc1
    s_add_u32 s3, s3, 86144
    buffer_load_dwordx4 v[72:75], v20, s[24:27], s3 offen sc1
    s_add_u32 s3, s3, 86144
    buffer_load_dwordx4 v[76:79], v20, s[24:27], s3 offen sc1
    s_add_u32 s3, s3, 86144
    buffer_load_dwordx4 v[80:83], v20, s[24:27], s3 offen sc1
    s_add_u32 s3, s3, 86144
    buffer_load_dwordx4 v[84:87], v20, s[24:27], s3 offen sc1
    s_add_u32 s3, s3, 86144
    buffer_load_dwordx4 v[88:91], v20, s[24:27], s3 offen sc1
    s_add_u32 s3, s3, 86144
    buffer_load_dwordx4 v[92:95], v20, s[24:27], s3 offen sc1
    buffer_load_dword v27, v26, s[20:23], 0 offen offset:1024 sc1
    s_waitcnt vmcnt(8)
    v_mfma_f32_32x32x16_bf16 v[128:143], v[60:63], v[64:67], 0
    s_waitcnt vmcnt(7)
    v_mfma_f32_32x32x16_bf16 v[128:143], v[60:63], v[68:71], v[128:143]
    s_waitcnt vmcnt(6)
    v_mfma_f32_32x32x16_bf16 v[128:143], v[60:63], v[72:75], v[128:143]
    s_waitcnt vmcnt(5)
    v_mfma_f32_32x32x16_bf16 v[128:143], v[60:63], v[76:79], v[128:143]
    s_waitcnt vmcnt(4)
    v_mfma_f32_32x32x16_bf16 v[128:143], v[60:63], v[80:83], v[128:143]
    s_waitcnt vmcnt(3)
    v_mfma_f32_32x32x16_bf16 v[128:143], v[60:63], v[84:87], v[128:143]
    s_waitcnt vmcnt(2)
    v_mfma_f32_32x32x16_bf16 v[128:143], v[60:63], v[88:91], v[128:143]
    s_waitcnt vmcnt(1)
    v_mfma_f32_32x32x16_bf16 v[128:143], v[60:63], v[92:95], v[128:143]
    s_nop 11
    v_cvt_pk_bf16_f32 v52, v128, v129
    v_cvt_pk_bf16_f32 v53, v130, v131
    v_cvt_pk_bf16_f32 v54, v132, v133
    v_cvt_pk_bf16_f32 v55, v134, v135
    buffer_store_dwordx4 v[52:55], v21, s[28:31], 0 offen
    s_waitcnt vmcnt(1)
    v_cmp_ne_u32 vcc, s64, v27
    s_nop 0
    s_cbranch_vccz L_pdoneB1
    s_mov_b32 s65, 0
L_pollB1:
    buffer_load_dword v27, v26, s[20:23], 0 offen offset:1024 sc1
    s_waitcnt vmcnt(0)
    v_cmp_ne_u32 vcc, s64, v27
    s_add_u32 s65, s65, 1
    s_cbranch_vccz L_pdoneB1
    s_sleep 1
    s_cmp_lt_u32 s65, 20000
    s_cbranch_scc1 L_pollB1
L_pdoneB1:
    s_mov_b32 s3, 67584
    buffer_load_dwordx4 v[96:99], v20, s[24:27], s3 offen sc1
    s_add_u32 s3, s3, 86144
    buffer_load_dwordx4 v[100:103], v20, s[24:27], s3 offen sc1
    s_add_u32 s3, s3, 86144
    buffer_load_dwordx4 v[104:107], v20, s[24:27], s3 offen sc1
    s_add_u32 s3, s3, 86144
    buffer_load_dwordx4 v[108:111], v20, s[24:27], s3 offen sc1
    s_add_u32 s3, s3, 86144
    buffer_load_dwordx4 v[112:115], v20, s[24:27], s3 offen sc1
    s_add_u32 s3, s3, 86144
    buffer_load_dwordx4 v[116:119], v20, s[24:27], s3 offen sc1
    s_add_u32 s3, s3, 86144
    buffer_load_dwordx4 v[120:123], v20, s[24:27], s3 offen sc1
    s_add_u32 s3, s3, 86144
    buffer_load_dwordx4 v[124:127], v20, s[24:27], s3 offen sc1
    s_waitcnt vmcnt(7)
    v_mfma_f32_32x32x16_bf16 v[144:159], v[60:63], v[96:99], 0
    s_waitcnt vmcnt(6)
    v_mfma_f32_32x32x16_bf16 v[144:159], v[60:63], v[100:103], v[144:159]
    s_waitcnt vmcnt(5)
    v_mfma_f32_32x32x16_bf16 v[144:159], v[60:63], v[104:107], v[144:159]
    s_waitcnt vmcnt(4)
    v_mfma_f32_32x32x16_bf16 v[144:159], v[60:63], v[108:111], v[144:159]
    s_waitcnt vmcnt(3)
    v_mfma_f32_32x32x16_bf16 v[144:159], v[60:63], v[112:115], v[144:159]
    s_waitcnt vmcnt(2)
    v_mfma_f32_32x32x16_bf16 v[144:159], v[60:63], v[116:119], v[144:159]
    s_waitcnt vmcnt(1)
    v_mfma_f32_32x32x16_bf16 v[144:159], v[60:63], v[120:123], v[144:159]
    s_waitcnt vmcnt(0)
    v_mfma_f32_32x32x16_bf16 v[144:159], v[60:63], v[124:127], v[144:159]
    s_nop 11
    v_cvt_pk_bf16_f32 v48, v144, v145
    v_cvt_pk_bf16_f32 v49, v146, v147
    v_cvt_pk_bf16_f32 v50, v148, v149
    v_cvt_pk_bf16_f32 v51, v150, v151
    buffer_store_dwordx4 v[48:51], v21, s[28:31], 0 offen offset:64
L_final:
    s_endpgm
L_w3:
    s_mov_b32 s52, 40960
    s_nop 8
    v_mul_f32 v224, v224, v18
    v_mul_f32 v225, v225, v18
    v_cvt_pk_bf16_f32 v36, v224, v225
    v_mul_f32 v226, v226, v18
    v_mul_f32 v227, v227, v18
    v_cvt_pk_bf16_f32 v37, v226, v227
    v_mul_f32 v228, v228, v18
    v_mul_f32 v229, v229, v18
    v_cvt_pk_bf16_f32 v38, v228, v229
    v_mul_f32 v230, v230, v18
    v_mul_f32 v231, v231, v18
    v_cvt_pk_bf16_f32 v39, v230, v231
    buffer_store_dwordx4 v[36:39], v6, s[40:43], s52 offen sc1
    v_mul_f32 v232, v232, v18
    v_mul_f32 v233, v233, v18
    v_cvt_pk_bf16_f32 v40, v232, v233
    v_mul_f32 v234, v234, v18
    v_mul_f32 v235, v235, v18
    v_cvt_pk_bf16_f32 v41, v234, v235
    v_mul_f32 v236, v236, v18
    v_mul_f32 v237, v237, v18
    v_cvt_pk_bf16_f32 v42, v236, v237
    v_mul_f32 v238, v238, v18
    v_mul_f32 v239, v239, v18
    v_cvt_pk_bf16_f32 v43, v238, v239
    buffer_store_dwordx4 v[40:43], v6, s[40:43], s52 offen offset:1024 sc1
    s_lshl_b32 s3, s46, 10
    v_lshl_add_u32 v56, v1, 4, s3
    s_lshr_b32 s3, s46, 3
    s_lshl_b32 s55, s3, 6
    s_bfe_u32 s3, s46, 0x20001
    s_lshl_b32 s3, s3, 8
    s_add_u32 s55, s55, s3
    s_and_b32 s3, s46, 1
    s_lshl_b32 s3, s3, 4
    s_add_u32 s55, s55, s3
    v_and_b32 v57, 31, v1
    v_mul_u32_u24 v57, 896, v57
    v_lshrrev_b32 v58, 5, v1
    v_lshl_add_u32 v57, v58, 5, v57
    v_add_u32 v57, s55, v57
    s_bfe_u32 s3, s46, 0x20001
    s_lshl_b32 s3, s3, 6
    s_lshl_b32 s55, s46, 11
    s_add_u32 s3, s3, s55
    v_and_b32 v8, 15, v1
    v_lshl_add_u32 v8, v8, 2, s3
    s_waitcnt lgkmcnt(0)
    v_bfe_u32 v22, v1, 3, 1
    v_bfe_u32 v23, v1, 1, 1
    v_lshl_add_u32 v22, v22, 1, v23
    v_and_b32 v23, 1, v1
    v_lshlrev_b32 v23, 4, v23
    v_mov_b32 v24, 0x3f80
    v_lshlrev_b32 v23, v23, v24
    v_bfe_u32 v24, v1, 4, 1
    v_lshl_add_u32 v22, v24, 2, v22
    v_bfe_u32 v24, v1, 2, 1
    v_lshrrev_b32 v60, 5, v1
    v_xor_b32 v24, v24, v60
    v_lshl_add_u32 v22, v24, 3, v22
    v_cmp_eq_u32 vcc, 0, v22
    s_nop 1
    v_cndmask_b32 v60, 0, v23, vcc
    v_cmp_eq_u32 vcc, 1, v22
    s_nop 1
    v_cndmask_b32 v61, 0, v23, vcc
    v_cmp_eq_u32 vcc, 2, v22
    s_nop 1
    v_cndmask_b32 v62, 0, v23, vcc
    v_cmp_eq_u32 vcc, 3, v22
    s_nop 1
    v_cndmask_b32 v63, 0, v23, vcc
    buffer_store_dword v14, v9, s[20:23], s68 offen sc1
    s_waitcnt vmcnt(5)
    buffer_store_dword v14, v9, s[20:23], s68 offen offset:256 sc1
    s_waitcnt vmcnt(2)
    buffer_store_dword v14, v9, s[20:23], s68 offen offset:512 sc1
    s_mov_b32 s65, 0
L_pollA0:
    buffer_load_dword v27, v8, s[20:23], 0 offen sc1
    s_waitcnt vmcnt(0)
    v_cmp_ne_u32 vcc, s64, v27
    s_add_u32 s65, s65, 1
    s_cbranch_vccz L_pdoneA0
    s_sleep 1
    s_cmp_lt_u32 s65, 20000
    s_cbranch_scc1 L_pollA0
L_pdoneA0:
    buffer_load_dword v27, v8, s[20:23], 0 offen offset:256 sc1
    s_mov_b32 s3, 0
    buffer_load_dwordx4 v[64:67], v56, s[24:27], s3 offen sc1
    s_add_u32 s3, s3, 86144
    buffer_load_dwordx4 v[68:71], v56, s[24:27], s3 offen sc1
    s_add_u32 s3, s3, 86144
    buffer_load_dwordx4 v[72:75], v56, s[24:27], s3 offen sc1
    s_add_u32 s3, s3, 86144
    buffer_load_dwordx4 v[76:79], v56, s[24:27], s3 offen sc1
    s_add_u32 s3, s3, 86144
    buffer_load_dwordx4 v[80:83], v56, s[24:27], s3 offen sc1
    s_add_u32 s3, s3, 86144
    buffer_load_dwordx4 v[84:87], v56, s[24:27], s3 offen sc1
    s_add_u32 s3, s3, 86144
    buffer_load_dwordx4 v[88:91], v56, s[24:27], s3 offen sc1
    s_add_u32 s3, s3, 86144
    buffer_load_dwordx4 v[92:95], v56, s[24:27], s3 offen sc1
    s_add_u32 s3, s3, 86144
    buffer_load_dwordx4 v[96:99], v56, s[24:27], s3 offen sc1
    s_add_u32 s3, s3, 86144
    buffer_load_dwordx4 v[100:103], v56, s[24:27], s3 offen sc1
    s_add_u32 s3, s3, 86144
    buffer_load_dwordx4 v[104:107], v56, s[24:27], s3 offen sc1
    s_add_u32 s3, s3, 86144
    buffer_load_dwordx4 v[108:111], v56, s[24:27], s3 offen sc1
    s_add_u32 s3, s3, 86144
    buffer_load_dwordx4 v[112:115], v56, s[24:27], s3 offen sc1
    s_add_u32 s3, s3, 86144
    buffer_load_dwordx4 v[116:119], v56, s[24:27], s3 offen sc1
    s_add_u32 s3, s3, 86144
    buffer_load_dwordx4 v[120:123], v56, s[24:27], s3 offen sc1
    s_add_u32 s3, s3, 86144
    buffer_load_dwordx4 v[124:127], v56, s[24:27], s3 offen sc1
    s_waitcnt vmcnt(16)
    v_cmp_ne_u32 vcc, s64, v27
    s_nop 0
    s_cbranch_vccz L_pdoneA1
    s_mov_b32 s65, 0
L_pollA1:
    buffer_load_dword v27, v8, s[20:23], 0 offen offset:256 sc1
    s_waitcnt vmcnt(0)
    v_cmp_ne_u32 vcc, s64, v27
    s_add_u32 s65, s65, 1
    s_cbranch_vccz L_pdoneA1
    s_sleep 1
    s_cmp_lt_u32 s65, 20000
    s_cbranch_scc1 L_pollA1
L_pdoneA1:
    buffer_load_dword v27, v8, s[20:23], 0 offen offset:512 sc1
    s_mov_b32 s3, 16384
    buffer_load_dwordx4 v[128:131], v56, s[24:27], s3 offen sc1
    s_add_u32 s3, s3, 86144
    buffer_load_dwordx4 v[132:135], v56, s[24:27], s3 offen sc1
    s_add_u32 s3, s3, 86144
    buffer_load_dwordx4 v[136:139], v56, s[24:27], s3 offen sc1
    s_add_u32 s3, s3, 86144
    buffer_load_dwordx4 v[140:143], v56, s[24:27], s3 offen sc1
    s_add_u32 s3, s3, 86144
    buffer_load_dwordx4 v[144:147], v56, s[24:27], s3 offen sc1
    s_add_u32 s3, s3, 86144
    buffer_load_dwordx4 v[148:151], v56, s[24:27], s3 offen sc1
    s_add_u32 s3, s3, 86144
    buffer_load_dwordx4 v[152:155], v56, s[24:27], s3 offen sc1
    s_add_u32 s3, s3, 86144
    buffer_load_dwordx4 v[156:159], v56, s[24:27], s3 offen sc1
    s_add_u32 s3, s3, 86144
    buffer_load_dwordx4 v[160:163], v56, s[24:27], s3 offen sc1
    s_add_u32 s3, s3, 86144
    buffer_load_dwordx4 v[164:167], v56, s[24:27], s3 offen sc1
    s_add_u32 s3, s3, 86144
    buffer_load_dwordx4 v[168:171], v56, s[24:27], s3 offen sc1
    s_add_u32 s3, s3, 86144
    buffer_load_dwordx4 v[172:175], v56, s[24:27], s3 offen sc1
    s_add_u32 s3, s3, 86144
    buffer_load_dwordx4 v[176:179], v56, s[24:27], s3 offen sc1
    s_add_u32 s3, s3, 86144
    buffer_load_dwordx4 v[180:183], v56, s[24:27], s3 offen sc1
    s_add_u32 s3, s3, 86144
    buffer_load_dwordx4 v[184:187], v56, s[24:27], s3 offen sc1
    s_add_u32 s3, s3, 86144
    buffer_load_dwordx4 v[188:191], v56, s[24:27], s3 offen sc1
    s_mov_b32 s55, 0
    s_waitcnt vmcnt(17)
    v_mfma_f32_32x32x16_bf16 v[28:43], v[60:63], v[64:67], 0
    v_mfma_f32_32x32x16_bf16 v[28:43], v[60:63], v[68:71], v[28:43]
    v_mfma_f32_32x32x16_bf16 v[28:43], v[60:63], v[72:75], v[28:43]
    v_mfma_f32_32x32x16_bf16 v[28:43], v[60:63], v[76:79], v[28:43]
    v_mfma_f32_32x32x16_bf16 v[28:43], v[60:63], v[80:83], v[28:43]
    v_mfma_f32_32x32x16_bf16 v[28:43], v[60:63], v[84:87], v[28:43]
    v_mfma_f32_32x32x16_bf16 v[28:43], v[60:63], v[88:91], v[28:43]
    v_mfma_f32_32x32x16_bf16 v[28:43], v[60:63], v[92:95], v[28:43]
    v_mfma_f32_32x32x16_bf16 v[28:43], v[60:63], v[96:99], v[28:43]
    v_mfma_f32_32x32x16_bf16 v[28:43], v[60:63], v[100:103], v[28:43]
    v_mfma_f32_32x32x16_bf16 v[28:43], v[60:63], v[104:107], v[28:43]
    v_mfma_f32_32x32x16_bf16 v[28:43], v[60:63], v[108:111], v[28:43]
    v_mfma_f32_32x32x16_bf16 v[28:43], v[60:63], v[112:115], v[28:43]
    v_mfma_f32_32x32x16_bf16 v[28:43], v[60:63], v[116:119], v[28:43]
    v_mfma_f32_32x32x16_bf16 v[28:43], v[60:63], v[120:123], v[28:43]
    v_mfma_f32_32x32x16_bf16 v[28:43], v[60:63], v[124:127], v[28:43]
    s_nop 11
    v_cvt_pk_bf16_f32 v52, v28, v29
    v_cvt_pk_bf16_f32 v53, v30, v31
    v_cvt_pk_bf16_f32 v54, v32, v33
    v_cvt_pk_bf16_f32 v55, v34, v35
    buffer_store_dwordx4 v[52:55], v57, s[28:31], s55 offen
    s_waitcnt vmcnt(17)
    v_cmp_ne_u32 vcc, s64, v27
    s_nop 0
    s_cbranch_vccz L_pdoneA2
    s_mov_b32 s65, 0
L_pollA2:
    buffer_load_dword v27, v8, s[20:23], 0 offen offset:512 sc1
    s_waitcnt vmcnt(0)
    v_cmp_ne_u32 vcc, s64, v27
    s_add_u32 s65, s65, 1
    s_cbranch_vccz L_pdoneA2
    s_sleep 1
    s_cmp_lt_u32 s65, 20000
    s_cbranch_scc1 L_pollA2
L_pdoneA2:
    s_mov_b32 s3, 32768
    buffer_load_dwordx4 v[192:195], v56, s[24:27], s3 offen sc1
    s_add_u32 s3, s3, 86144
    buffer_load_dwordx4 v[196:199], v56, s[24:27], s3 offen sc1
    s_add_u32 s3, s3, 86144
    buffer_load_dwordx4 v[200:203], v56, s[24:27], s3 offen sc1
    s_add_u32 s3, s3, 86144
    buffer_load_dwordx4 v[204:207], v56, s[24:27], s3 offen sc1
    s_add_u32 s3, s3, 86144
    buffer_load_dwordx4 v[208:211], v56, s[24:27], s3 offen sc1
    s_add_u32 s3, s3, 86144
    buffer_load_dwordx4 v[212:215], v56, s[24:27], s3 offen sc1
    s_add_u32 s3, s3, 86144
    buffer_load_dwordx4 v[216:219], v56, s[24:27], s3 offen sc1
    s_add_u32 s3, s3, 86144
    buffer_load_dwordx4 v[220:223], v56, s[24:27], s3 offen sc1
    s_add_u32 s3, s3, 86144
    buffer_load_dwordx4 v[224:227], v56, s[24:27], s3 offen sc1
    s_add_u32 s3, s3, 86144
    buffer_load_dwordx4 v[228:231], v56, s[24:27], s3 offen sc1
    s_add_u32 s3, s3, 86144
    buffer_load_dwordx4 v[232:235], v56, s[24:27], s3 offen sc1
    s_add_u32 s3, s3, 86144
    buffer_load_dwordx4 v[236:239], v56, s[24:27], s3 offen sc1
    s_add_u32 s3, s3, 86144
    buffer_load_dwordx4 v[240:243], v56, s[24:27], s3 offen sc1
    s_add_u32 s3, s3, 86144
    buffer_load_dwordx4 v[244:247], v56, s[24:27], s3 offen sc1
    s_add_u32 s3, s3, 86144
    buffer_load_dwordx4 v[248:251], v56, s[24:27], s3 offen sc1
    s_add_u32 s3, s3, 86144
    buffer_load_dwordx4 v[252:255], v56, s[24:27], s3 offen sc1
    s_mov_b32 s55, 28672
    s_waitcnt vmcnt(17)
    v_mfma_f32_32x32x16_bf16 v[28:43], v[60:63], v[128:131], 0
    v_mfma_f32_32x32x16_bf16 v[28:43], v[60:63], v[132:135], v[28:43]
    v_mfma_f32_32x32x16_bf16 v[28:43], v[60:63], v[136:139], v[28:43]
    v_mfma_f32_32x32x16_bf16 v[28:43], v[60:63], v[140:143], v[28:43]
    v_mfma_f32_32x32x16_bf16 v[28:43], v[60:63], v[144:147], v[28:43]
    v_mfma_f32_32x32x16_bf16 v[28:43], v[60:63], v[148:151], v[28:43]
    v_mfma_f32_32x32x16_bf16 v[28:43], v[60:63], v[152:155], v[28:43]
    v_mfma_f32_32x32x16_bf16 v[28:43], v[60:63], v[156:159], v[28:43]
    v_mfma_f32_32x32x16_bf16 v[28:43], v[60:63], v[160:163], v[28:43]
    v_mfma_f32_32x32x16_bf16 v[28:43], v[60:63], v[164:167], v[28:43]
    v_mfma_f32_32x32x16_bf16 v[28:43], v[60:63], v[168:171], v[28:43]
    v_mfma_f32_32x32x16_bf16 v[28:43], v[60:63], v[172:175], v[28:43]
    v_mfma_f32_32x32x16_bf16 v[28:43], v[60:63], v[176:179], v[28:43]
    v_mfma_f32_32x32x16_bf16 v[28:43], v[60:63], v[180:183], v[28:43]
    v_mfma_f32_32x32x16_bf16 v[28:43], v[60:63], v[184:187], v[28:43]
    v_mfma_f32_32x32x16_bf16 v[28:43], v[60:63], v[188:191], v[28:43]
    s_nop 11
    v_cvt_pk_bf16_f32 v48, v28, v29
    v_cvt_pk_bf16_f32 v49, v30, v31
    v_cvt_pk_bf16_f32 v50, v32, v33
    v_cvt_pk_bf16_f32 v51, v34, v35
    buffer_store_dwordx4 v[48:51], v57, s[28:31], s55 offen
    s_mov_b32 s55, 57344
    s_waitcnt vmcnt(16)
    v_mfma_f32_32x32x16_bf16 v[28:43], v[60:63], v[192:195], 0
    s_waitcnt vmcnt(15)
    v_mfma_f32_32x32x16_bf16 v[28:43], v[60:63], v[196:199], v[28:43]
    s_waitcnt vmcnt(14)
    v_mfma_f32_32x32x16_bf16 v[28:43], v[60:63], v[200:203], v[28:43]
    s_waitcnt vmcnt(13)
    v_mfma_f32_32x32x16_bf16 v[28:43], v[60:63], v[204:207], v[28:43]
    s_waitcnt vmcnt(12)
    v_mfma_f32_32x32x16_bf16 v[28:43], v[60:63], v[208:211], v[28:43]
    s_waitcnt vmcnt(11)
    v_mfma_f32_32x32x16_bf16 v[28:43], v[60:63], v[212:215], v[28:43]
    s_waitcnt vmcnt(10)
    v_mfma_f32_32x32x16_bf16 v[28:43], v[60:63], v[216:219], v[28:43]
    s_waitcnt vmcnt(9)
    v_mfma_f32_32x32x16_bf16 v[28:43], v[60:63], v[220:223], v[28:43]
    s_waitcnt vmcnt(8)
    v_mfma_f32_32x32x16_bf16 v[28:43], v[60:63], v[224:227], v[28:43]
    s_waitcnt vmcnt(7)
    v_mfma_f32_32x32x16_bf16 v[28:43], v[60:63], v[228:231], v[28:43]
    s_waitcnt vmcnt(6)
    v_mfma_f32_32x32x16_bf16 v[28:43], v[60:63], v[232:235], v[28:43]
    s_waitcnt vmcnt(5)
    v_mfma_f32_32x32x16_bf16 v[28:43], v[60:63], v[236:239], v[28:43]
    s_waitcnt vmcnt(4)
    v_mfma_f32_32x32x16_bf16 v[28:43], v[60:63], v[240:243], v[28:43]
    s_waitcnt vmcnt(3)
    v_mfma_f32_32x32x16_bf16 v[28:43], v[60:63], v[244:247], v[28:43]
    s_waitcnt vmcnt(2)
    v_mfma_f32_32x32x16_bf16 v[28:43], v[60:63], v[248:251], v[28:43]
    s_waitcnt vmcnt(1)
    v_mfma_f32_32x32x16_bf16 v[28:43], v[60:63], v[252:255], v[28:43]
    s_nop 11
    v_cvt_pk_bf16_f32 v52, v28, v29
    v_cvt_pk_bf16_f32 v53, v30, v31
    v_cvt_pk_bf16_f32 v54, v32, v33
    v_cvt_pk_bf16_f32 v55, v34, v35
    buffer_store_dwordx4 v[52:55], v57, s[28:31], s55 offen
    s_cmp_lg_u32 s46, 0
    s_cbranch_scc1 L_final
    v_mov_b32 v8, s66
    global_store_dword v8, v14, s[16:17]
    s_branch L_final
L_rare:
    s_nop 15
    s_waitcnt lgkmcnt(0)
    v_and_b32 v28, 31, v1
    v_lshlrev_b32 v28, 4, v28
    v_add_u32 v28, 156672, v28
    v_lshl_add_u32 v29, s48, 2, v28
    v_max3_f32 v22, v112, v113, v114
    v_max3_f32 v22, v22, v115, v116
    v_max3_f32 v22, v22, v117, v118
    v_max3_f32 v22, v22, v119, v120
    v_max3_f32 v22, v22, v121, v122
    v_max3_f32 v22, v22, v123, v124
    v_max3_f32 v22, v22, v125, v126
    v_max_f32 v22, v22, v127
    v_mov_b32 v23, v22
    s_nop 1
    v_permlane32_swap_b32 v22, v23
    v_max_f32 v22, v22, v23
    ds_write_b32 v29, v22 offset:0
    v_max3_f32 v22, v128, v129, v130
    v_max3_f32 v22, v22, v131, v132
    v_max3_f32 v22, v22, v133, v134
    v_max3_f32 v22, v22, v135, v136
    v_max3_f32 v22, v22, v137, v138
    v_max3_f32 v22, v22, v139, v140
    v_max3_f32 v22, v22, v141, v142
    v_max_f32 v22, v22, v143
    v_mov_b32 v23, v22
    s_nop 1
    v_permlane32_swap_b32 v22, v23
    v_max_f32 v22, v22, v23
    ds_write_b32 v29, v22 offset:512
    v_max3_f32 v22, v144, v145, v146
    v_max3_f32 v22, v22, v147, v148
    v_max3_f32 v22, v22, v149, v150
    v_max3_f32 v22, v22, v151, v152
    v_max3_f32 v22, v22, v153, v154
    v_max3_f32 v22, v22, v155, v156
    v_max3_f32 v22, v22, v157, v158
    v_max_f32 v22, v22, v159
    v_mov_b32 v23, v22
    s_nop 1
    v_permlane32_swap_b32 v22, v23
    v_max_f32 v22, v22, v23
    ds_write_b32 v29, v22 offset:1024
    s_waitcnt lgkmcnt(0)
    s_barrier
    ds_read_b128 v[32:35], v28 offset:0
    s_waitcnt lgkmcnt(0)
    v_max3_f32 v30, v32, v33, v34
    v_max3_f32 v30, v30, v35, 0
    v_exp_f32 v31, -v30
    v_sub_f32 v13, v13, v30
    v_sub_f32 v112, v112, v30
    v_sub_f32 v113, v113, v30
    v_sub_f32 v114, v114, v30
    v_sub_f32 v115, v115, v30
    v_sub_f32 v116, v116, v30
    v_sub_f32 v117, v117, v30
    v_sub_f32 v118, v118, v30
    v_sub_f32 v119, v119, v30
    v_sub_f32 v120, v120, v30
    v_sub_f32 v121, v121, v30
    v_sub_f32 v122, v122, v30
    v_sub_f32 v123, v123, v30
    v_sub_f32 v124, v124, v30
    v_sub_f32 v125, v125, v30
    v_sub_f32 v126, v126, v30
    v_sub_f32 v127, v127, v30
    v_mul_f32 v16, v16, v31
    v_mul_f32 v160, v160, v31
    v_mul_f32 v161, v161, v31
    v_mul_f32 v162, v162, v31
    v_mul_f32 v163, v163, v31
    v_mul_f32 v164, v164, v31
    v_mul_f32 v165, v165, v31
    v_mul_f32 v166, v166, v31
    v_mul_f32 v167, v167, v31
    v_mul_f32 v168, v168, v31
    v_mul_f32 v169, v169, v31
    v_mul_f32 v170, v170, v31
    v_mul_f32 v171, v171, v31
    v_mul_f32 v172, v172, v31
    v_mul_f32 v173, v173, v31
    v_mul_f32 v174, v174, v31
    v_mul_f32 v175, v175, v31
    v_mul_f32 v208, v208, v31
    v_mul_f32 v209, v209, v31
    v_mul_f32 v210, v210, v31
    v_mul_f32 v211, v211, v31
    v_mul_f32 v212, v212, v31
    v_mul_f32 v213, v213, v31
    v_mul_f32 v214, v214, v31
    v_mul_f32 v215, v215, v31
    v_mul_f32 v216, v216, v31
    v_mul_f32 v217, v217, v31
    v_mul_f32 v218, v218, v31
    v_mul_f32 v219, v219, v31
    v_mul_f32 v220, v220, v31
    v_mul_f32 v221, v221, v31
    v_mul_f32 v222, v222, v31
    v_mul_f32 v223, v223, v31
    v_exp_f32 v22, v112
    v_exp_f32 v23, v113
    v_exp_f32 v24, v114
    v_exp_f32 v25, v115
    v_add_f32 v19, v22, v23
    v_cvt_pk_bf16_f32 v88, v22, v23
    v_exp_f32 v26, v116
    v_exp_f32 v27, v117
    v_add_f32 v19, v19, v24
    v_cvt_pk_bf16_f32 v89, v24, v25
    v_add_f32 v19, v19, v25
    v_exp_f32 v22, v118
    v_exp_f32 v23, v119
    v_add_f32 v19, v19, v26
    v_cvt_pk_bf16_f32 v90, v26, v27
    v_add_f32 v19, v19, v27
    v_exp_f32 v24, v120
    v_exp_f32 v25, v121
    v_add_f32 v19, v19, v22
    v_cvt_pk_bf16_f32 v91, v22, v23
    v_add_f32 v19, v19, v23
    v_exp_f32 v26, v122
    v_exp_f32 v27, v123
    v_add_f32 v19, v19, v24
    v_cvt_pk_bf16_f32 v92, v24, v25
    v_add_f32 v19, v19, v25
    v_exp_f32 v22, v124
    v_exp_f32 v23, v125
    v_add_f32 v19, v19, v26
    v_cvt_pk_bf16_f32 v93, v26, v27
    v_add_f32 v19, v19, v27
    v_exp_f32 v24, v126
    v_exp_f32 v25, v127
    v_add_f32 v19, v19, v22
    v_cvt_pk_bf16_f32 v94, v22, v23
    v_add_f32 v19, v19, v23
    v_add_f32 v19, v19, v24
    v_cvt_pk_bf16_f32 v95, v24, v25
    v_add_f32 v19, v19, v25
    ds_read_b128 v[32:35], v28 offset:512
    s_waitcnt lgkmcnt(0)
    v_max3_f32 v30, v32, v33, v34
    v_max3_f32 v30, v30, v35, 0
    v_exp_f32 v31, -v30
    v_sub_f32 v14, v14, v30
    v_sub_f32 v128, v128, v30
    v_sub_f32 v129, v129, v30
    v_sub_f32 v130, v130, v30
    v_sub_f32 v131, v131, v30
    v_sub_f32 v132, v132, v30
    v_sub_f32 v133, v133, v30
    v_sub_f32 v134, v134, v30
    v_sub_f32 v135, v135, v30
    v_sub_f32 v136, v136, v30
    v_sub_f32 v137, v137, v30
    v_sub_f32 v138, v138, v30
    v_sub_f32 v139, v139, v30
    v_sub_f32 v140, v140, v30
    v_sub_f32 v141, v141, v30
    v_sub_f32 v142, v142, v30
    v_sub_f32 v143, v143, v30
    v_mul_f32 v17, v17, v31
    v_mul_f32 v176, v176, v31
    v_mul_f32 v177, v177, v31
    v_mul_f32 v178, v178, v31
    v_mul_f32 v179, v179, v31
    v_mul_f32 v180, v180, v31
    v_mul_f32 v181, v181, v31
    v_mul_f32 v182, v182, v31
    v_mul_f32 v183, v183, v31
    v_mul_f32 v184, v184, v31
    v_mul_f32 v185, v185, v31
    v_mul_f32 v186, v186, v31
    v_mul_f32 v187, v187, v31
    v_mul_f32 v188, v188, v31
    v_mul_f32 v189, v189, v31
    v_mul_f32 v190, v190, v31
    v_mul_f32 v191, v191, v31
    v_mul_f32 v224, v224, v31
    v_mul_f32 v225, v225, v31
    v_mul_f32 v226, v226, v31
    v_mul_f32 v227, v227, v31
    v_mul_f32 v228, v228, v31
    v_mul_f32 v229, v229, v31
    v_mul_f32 v230, v230, v31
    v_mul_f32 v231, v231, v31
    v_mul_f32 v232, v232, v31
    v_mul_f32 v233, v233, v31
    v_mul_f32 v234, v234, v31
    v_mul_f32 v235, v235, v31
    v_mul_f32 v236, v236, v31
    v_mul_f32 v237, v237, v31
    v_mul_f32 v238, v238, v31
    v_mul_f32 v239, v239, v31
    v_exp_f32 v22, v128
    v_exp_f32 v23, v129
    v_exp_f32 v24, v130
    v_exp_f32 v25, v131
    v_add_f32 v20, v22, v23
    v_cvt_pk_bf16_f32 v96, v22, v23
    v_exp_f32 v26, v132
    v_exp_f32 v27, v133
    v_add_f32 v20, v20, v24
    v_cvt_pk_bf16_f32 v97, v24, v25
    v_add_f32 v20, v20, v25
    v_exp_f32 v22, v134
    v_exp_f32 v23, v135
    v_add_f32 v20, v20, v26
    v_cvt_pk_bf16_f32 v98, v26, v27
    v_add_f32 v20, v20, v27
    v_exp_f32 v24, v136
    v_exp_f32 v25, v137
    v_add_f32 v20, v20, v22
    v_cvt_pk_bf16_f32 v99, v22, v23
    v_add_f32 v20, v20, v23
    v_exp_f32 v26, v138
    v_exp_f32 v27, v139
    v_add_f32 v20, v20, v24
    v_cvt_pk_bf16_f32 v100, v24, v25
    v_add_f32 v20, v20, v25
    v_exp_f32 v22, v140
    v_exp_f32 v23, v141
    v_add_f32 v20, v20, v26
    v_cvt_pk_bf16_f32 v101, v26, v27
    v_add_f32 v20, v20, v27
    v_exp_f32 v24, v142
    v_exp_f32 v25, v143
    v_add_f32 v20, v20, v22
    v_cvt_pk_bf16_f32 v102, v22, v23
    v_add_f32 v20, v20, v23
    v_add_f32 v20, v20, v24
    v_cvt_pk_bf16_f32 v103, v24, v25
    v_add_f32 v20, v20, v25
    ds_read_b128 v[32:35], v28 offset:1024
    s_waitcnt lgkmcnt(0)
    v_max3_f32 v30, v32, v33, v34
    v_max3_f32 v30, v30, v35, 0
    v_exp_f32 v31, -v30
    v_sub_f32 v15, v15, v30
    v_sub_f32 v144, v144, v30
    v_sub_f32 v145, v145, v30
    v_sub_f32 v146, v146, v30
    v_sub_f32 v147, v147, v30
    v_sub_f32 v148, v148, v30
    v_sub_f32 v149, v149, v30
    v_sub_f32 v150, v150, v30
    v_sub_f32 v151, v151, v30
    v_sub_f32 v152, v152, v30
    v_sub_f32 v153, v153, v30
    v_sub_f32 v154, v154, v30
    v_sub_f32 v155, v155, v30
    v_sub_f32 v156, v156, v30
    v_sub_f32 v157, v157, v30
    v_sub_f32 v158, v158, v30
    v_sub_f32 v159, v159, v30
    v_mul_f32 v18, v18, v31
    v_mul_f32 v192, v192, v31
    v_mul_f32 v193, v193, v31
    v_mul_f32 v194, v194, v31
    v_mul_f32 v195, v195, v31
    v_mul_f32 v196, v196, v31
    v_mul_f32 v197, v197, v31
    v_mul_f32 v198, v198, v31
    v_mul_f32 v199, v199, v31
    v_mul_f32 v200, v200, v31
    v_mul_f32 v201, v201, v31
    v_mul_f32 v202, v202, v31
    v_mul_f32 v203, v203, v31
    v_mul_f32 v204, v204, v31
    v_mul_f32 v205, v205, v31
    v_mul_f32 v206, v206, v31
    v_mul_f32 v207, v207, v31
    v_mul_f32 v240, v240, v31
    v_mul_f32 v241, v241, v31
    v_mul_f32 v242, v242, v31
    v_mul_f32 v243, v243, v31
    v_mul_f32 v244, v244, v31
    v_mul_f32 v245, v245, v31
    v_mul_f32 v246, v246, v31
    v_mul_f32 v247, v247, v31
    v_mul_f32 v248, v248, v31
    v_mul_f32 v249, v249, v31
    v_mul_f32 v250, v250, v31
    v_mul_f32 v251, v251, v31
    v_mul_f32 v252, v252, v31
    v_mul_f32 v253, v253, v31
    v_mul_f32 v254, v254, v31
    v_mul_f32 v255, v255, v31
    v_exp_f32 v22, v144
    v_exp_f32 v23, v145
    v_exp_f32 v24, v146
    v_exp_f32 v25, v147
    v_add_f32 v21, v22, v23
    v_cvt_pk_bf16_f32 v104, v22, v23
    v_exp_f32 v26, v148
    v_exp_f32 v27, v149
    v_add_f32 v21, v21, v24
    v_cvt_pk_bf16_f32 v105, v24, v25
    v_add_f32 v21, v21, v25
    v_exp_f32 v22, v150
    v_exp_f32 v23, v151
    v_add_f32 v21, v21, v26
    v_cvt_pk_bf16_f32 v106, v26, v27
    v_add_f32 v21, v21, v27
    v_exp_f32 v24, v152
    v_exp_f32 v25, v153
    v_add_f32 v21, v21, v22
    v_cvt_pk_bf16_f32 v107, v22, v23
    v_add_f32 v21, v21, v23
    v_exp_f32 v26, v154
    v_exp_f32 v27, v155
    v_add_f32 v21, v21, v24
    v_cvt_pk_bf16_f32 v108, v24, v25
    v_add_f32 v21, v21, v25
    v_exp_f32 v22, v156
    v_exp_f32 v23, v157
    v_add_f32 v21, v21, v26
    v_cvt_pk_bf16_f32 v109, v26, v27
    v_add_f32 v21, v21, v27
    v_exp_f32 v24, v158
    v_exp_f32 v25, v159
    v_add_f32 v21, v21, v22
    v_cvt_pk_bf16_f32 v110, v22, v23
    v_add_f32 v21, v21, v23
    v_add_f32 v21, v21, v24
    v_cvt_pk_bf16_f32 v111, v24, v25
    v_add_f32 v21, v21, v25
    s_nop 3
    s_cmp_lt_u32 s51, 8
    s_cbranch_scc1 L_rare_back
    ds_write_b128 v9, v[88:91] offset:0
    ds_write_b128 v9, v[92:95] offset:1024
    ds_write_b128 v9, v[96:99] offset:2048
    ds_write_b128 v9, v[100:103] offset:3072
    ds_write_b128 v9, v[104:107] offset:4096
    ds_write_b128 v9, v[108:111] offset:5120
    s_waitcnt lgkmcnt(0)
    s_branch L_rare_back6
L_flag:
    v_mov_b32 v22, s51
    ds_write_b32 v8, v22 offset:24576
    s_waitcnt lgkmcnt(0)
    s_cmp_ge_u32 s51, 7
    s_cbranch_scc1 L_flag_back6
    s_branch L_flag_back
L_exit:
    s_endpgm
L_end:
.section .rodata,"a"
.p2align 6
.amdhsa_kernel standalone__gqa_block_cached__near_ridge_kernel
  .amdhsa_next_free_vgpr 512
  .amdhsa_next_free_sgpr 102
  .amdhsa_accum_offset 256
  .amdhsa_group_segment_fixed_size 0
  .amdhsa_kernarg_size 64
  .amdhsa_user_sgpr_count 2
  .amdhsa_user_sgpr_kernarg_segment_ptr 1
  .amdhsa_system_sgpr_workgroup_id_x 1
.end_amdhsa_kernel
```
